```python
import torch

def _softmax(x, axis=-1):
    return torch.softmax(x, dim=axis)

def _gelu(x):
    return torch.nn.functional.gelu(x, approximate='tanh')

def _silu(x):
    return torch.nn.functional.silu(x)

def _sigmoid(x):
    return torch.sigmoid(x)

def _layernorm(x, axis=-1, eps=1e-05):
    m = x.mean(dim=axis, keepdim=True)
    v = x.var(dim=axis, keepdim=True, unbiased=False)
    return (x - m) / torch.sqrt(v + eps)

def _scatter_add(tgt, idx, src, axis=0):
    return tgt.clone().index_add_(axis, idx, src)

def _segment_sum(src, seg, n):
    out = torch.zeros((n,) + src.shape[1:], dtype=src.dtype)
    return out.index_add_(0, seg, src)

def _pad(x, pw):
    flat = tuple((v for pair in reversed(pw) for v in pair))
    return torch.nn.functional.pad(x, flat)
kernel_name = 'adaLN_cond__ssm_conv_s4__glu_gated_reglu__prompt'

def setup_inputs():

    _w = lambda a: (lambda t: t.to(torch.bfloat16) if t.is_floating_point() else t)(torch.as_tensor(a))

    def _A_setup():
        B, L, D, N = (1, 2048, 448, 256)
        A_re = -(lambda _x: torch.exp(torch.as_tensor(_x)))((lambda *s: torch.randn(*s, dtype=torch.bfloat16) * 3.2)(D, N))
        A_im = torch.pi * (lambda *s: torch.randn(*s, dtype=torch.bfloat16) * 0.1)(D, N)
        B_re = (lambda *s: torch.randn(*s, dtype=torch.bfloat16) * 0.1)(D, N)
        B_im = (lambda *s: torch.randn(*s, dtype=torch.bfloat16) * 0.1)(D, N)
        C_re = (lambda *s: torch.randn(*s, dtype=torch.bfloat16) * 0.1)(D, N)
        C_im = (lambda *s: torch.randn(*s, dtype=torch.bfloat16) * 0.1)(D, N)
        log_dt = (lambda *s: torch.randn(*s, dtype=torch.bfloat16) * 0.1)(D) * 0.5 - 4.0
        Dskip = (lambda *s: torch.randn(*s, dtype=torch.bfloat16) * 0.1)(D)
        return {'u': _w((lambda *s: torch.randn(*s, dtype=torch.bfloat16) * 0.05)(B, L, D)), 'A_re': _w(A_re), 'A_im': _w(A_im), 'B_re': _w(B_re), 'B_im': _w(B_im), 'C_re': _w(C_re), 'C_im': _w(C_im), 'log_dt': _w(log_dt), 'Dskip': _w(Dskip)}
    _A_in = _A_setup()

    def _B_setup():
        B, S, D, F = (1, 2048, 448, 1792)
        return {'x': _w((lambda *s: torch.randn(*s, dtype=torch.bfloat16) * 0.05)(B, S, D)), 'W_gate': _w((lambda *s: torch.randn(*s, dtype=torch.bfloat16) * 1.6)(D, F) * (2.0 / D) ** 0.5), 'W_up': _w((lambda *s: torch.randn(*s, dtype=torch.bfloat16) * 1.6)(D, F) * (2.0 / D) ** 0.5), 'W_down': _w((lambda *s: torch.randn(*s, dtype=torch.bfloat16) * 1.6)(F, D) * (1.0 / F) ** 0.5)}
    _B_in = _B_setup()
    return {'A_u': _A_in['u'], 'A_A_re': _A_in['A_re'], 'A_A_im': _A_in['A_im'], 'A_B_re': _A_in['B_re'], 'A_B_im': _A_in['B_im'], 'A_C_re': _A_in['C_re'], 'A_C_im': _A_in['C_im'], 'A_log_dt': _A_in['log_dt'], 'A_Dskip': _A_in['Dskip'], 'B_x': _B_in['x'], 'B_W_gate': _B_in['W_gate'], 'B_W_up': _B_in['W_up'], 'B_W_down': _B_in['W_down'], 'c': _w((lambda *s: torch.randn(*s, dtype=torch.bfloat16) * 0.2)(1, 448) * 8.0), 'w_mod': _w((lambda *s: torch.randn(*s, dtype=torch.bfloat16) * 0.2)(448, 6 * 448) * 448 ** (-0.5) * 8.0)}

def reference(A_u, A_A_re, A_A_im, A_B_re, A_B_im, A_C_re, A_C_im, A_log_dt, A_Dskip, B_x, B_W_gate, B_W_up, B_W_down, c, w_mod):

    def _A_ref(u, A_re, A_im, B_re, B_im, C_re, C_im, log_dt, Dskip):
        Bsz, L, D = u.shape
        dt = torch.exp(log_dt)[:, None]
        A = A_re + 1j * A_im
        Bc = B_re + 1j * B_im
        Cc = C_re + 1j * C_im
        logdA = dt * A
        dB = dt * Bc
        l = (lambda x, dt: x.to(dt))(torch.arange(L), A_re.dtype)
        P = torch.exp(logdA[:, :, None] * l[None, None, :])
        K = torch.einsum('dn,dnl,dn->dl', Cc, P, dB).real
        L2 = 2 * L
        Kp = _pad(K, ((0, 0), (0, L)))
        up = (lambda x, *d: x.permute(*d))(u, 0, 2, 1)
        up = _pad(up, ((0, 0), (0, 0), (0, L)))
        Kf = (lambda x, axes=(-2, -1): torch.fft.rfft2(x.float(), dim=axes))(Kp[:, None, :], axes=(-2, -1))
        Uf = (lambda x, axes=(-2, -1): torch.fft.rfft2(x.float(), dim=axes))(up[:, :, None, :], axes=(-2, -1))
        Yf = Uf * Kf[None, :, :, :]
        y = (lambda x, s, axes=(-2, -1): torch.fft.irfft2(x, s=s, dim=axes).to(torch.bfloat16))(Yf, (1, L2), axes=(-2, -1))[:, :, 0, :L]
        y = (lambda x, *d: x.permute(*d))(y, 0, 2, 1) + u * Dskip[None, None, :]
        return y

    def _B_ref(x, W_gate, W_up, W_down):
        gate = torch.einsum('bsd,df->bsf', x, W_gate)
        up = torch.einsum('bsd,df->bsf', x, W_up)
        gate = gate * (lambda x, dt: x.to(dt))(gate > 0, gate.dtype)
        h = gate * up
        return torch.einsum('bsf,fd->bsd', h, W_down)
    x = A_u
    mod = (_silu(c) @ w_mod).reshape(c.shape[0], 6, 1, -1)
    sa, ca, ga, sb, cb, gb = (mod[:, 0].clone(), mod[:, 1].clone(), mod[:, 2].clone(), mod[:, 3].clone(), mod[:, 4].clone(), mod[:, 5].clone())
    h = _layernorm(x, axis=-1) * (1 + ca) + sa
    x = x + ga * _A_ref(h, A_A_re, A_A_im, A_B_re, A_B_im, A_C_re, A_C_im, A_log_dt, A_Dskip)
    h = _layernorm(x, axis=-1) * (1 + cb) + sb
    x = x + gb * _B_ref(h, B_W_gate, B_W_up, B_W_down)
    return x
```

```asm
; @launch grid=(256,1,1) block=(512,1,1) lds=163840
.amdgcn_target "amdgcn-amd-amdhsa--gfx950"
.text
.globl adaLN_cond__ssm_conv_s4__glu_gated_reglu__prompt_kernel
.p2align 8
.type adaLN_cond__ssm_conv_s4__glu_gated_reglu__prompt_kernel,@function
adaLN_cond__ssm_conv_s4__glu_gated_reglu__prompt_kernel:
  s_cmp_ge_u32 s2, 256
  s_cbranch_scc1 F_end
  s_load_dwordx2 s[36:37], s[0:1], 0
  s_load_dwordx2 s[20:21], s[0:1], 136
  s_load_dwordx16 s[4:19], s[0:1], 8
  s_load_dwordx8 s[44:51], s[0:1], 80
  s_load_dwordx2 s[52:53], s[0:1], 112
  s_load_dwordx2 s[62:63], s[0:1], 120
  s_load_dwordx2 s[64:65], s[0:1], 80
  s_getpc_b64 s[22:23]
F_pc:
  s_add_u32 s22, s22, ktab-F_pc
  s_addc_u32 s23, s23, 0
  v_and_b32 v17, 255, v0
  v_lshlrev_b32 v17, 4, v17
  v_lshrrev_b32 v1, 6, v0
  v_and_b32 v2, 63, v0
  v_readfirstlane_b32 s33, v1
  s_lshr_b32 s3, s2, 3
  s_lshl_b32 s3, s3, 11
  v_lshrrev_b32 v3, 5, v0
  v_lshl_add_u32 v3, v3, 7, s3
  v_min_u32 v3, code_end-adaLN_cond__ssm_conv_s4__glu_gated_reglu__prompt_kernel-4, v3
  s_sub_u32 s24, s22, ktab-adaLN_cond__ssm_conv_s4__glu_gated_reglu__prompt_kernel
  s_subb_u32 s25, s23, 0
  global_load_dword v255, v3, s[24:25]
  global_load_dwordx4 v[20:23], v17, s[22:23]
  v_lshlrev_b32 v3, 4, v2
  s_and_b32 s34, s2, 1
  s_lshl_b32 s3, s2, 3
  s_mul_i32 s34, s34, 6
  s_sub_u32 s3, s3, s34
  s_and_b32 s34, s33, 6
  s_add_u32 s3, s3, s33
  s_add_u32 s3, s3, s34
  s_mul_i32 s3, s3, 896
  v_add_u32 v8, s3, v3
  v_mov_b32 v4, 0
  v_mov_b32 v5, 0
  v_mov_b32 v6, 0
  v_mov_b32 v7, 0
  s_and_b32 s34, s2, 7
  s_lshr_b32 s35, s2, 4
  s_lshl_b32 s35, s35, 3
  s_add_u32 s35, s35, s34
  s_lshl_b32 s35, s35, 1
  s_bfe_u32 s38, s2, 0x10003
  s_add_u32 s35, s35, s38
  s_lshr_b32 s38, s33, 2
  s_mov_b32 s43, 0
  s_mov_b32 s58, 115328
  s_mov_b32 s42, 1065369472
  s_lshl_b32 s3, s35, 10
  v_lshl_add_u32 v1, v0, 1, s3
  s_lshl_b32 s3, s35, 2
  v_bfe_u32 v10, v0, 5, 1
  v_mul_u32_u24 v10, 4608, v10
  v_and_b32 v11, 31, v0
  v_lshl_add_u32 v10, v11, 4, v10
  v_add_u32 v10, 110208, v10
  ds_write_b128 v10, v[4:7]
  v_mov_b32 v10, 0
  v_mov_b32 v11, 0
  v_mov_b32 v12, 0
  v_mov_b32 v13, 0
  v_mov_b32 v14, 0
  v_mov_b32 v15, 0
  v_mov_b32 v16, 0
  v_mov_b32 v18, 0
  s_cmp_ge_u32 s2, 224
  s_mov_b32 exec_hi, 0x00ffffff
  s_waitcnt lgkmcnt(0)
  global_load_dwordx4 v[4:7], v8, s[36:37] nt
  s_mov_b32 exec_hi, -1
  s_cbranch_scc1 F_spare_loads
  s_load_dword s40, s[20:21], 256
  s_load_dword s39, s[16:17], s3
  s_load_dword s41, s[18:19], s3
  s_and_b32 s27, s33, 3
  s_lshl_b32 s27, s27, 8
  s_mul_i32 s28, s38, 55104
  s_add_u32 s27, s27, s28
  v_and_b32 v24, 31, v2
  v_lshrrev_b32 v25, 5, v2
  v_mul_u32_u24 v210, 1040, v24
  v_lshl_add_u32 v210, v25, 4, v210
  v_add_u32 v210, s27, v210
  v_mul_u32_u24 v211, 4160, v25
  v_lshl_add_u32 v211, v24, 2, v211
  v_add_u32 v211, s27, v211
  v_lshrrev_b32 v206, 2, v0
  v_mul_u32_u24 v206, 28672, v206
  v_and_b32 v26, 3, v0
  v_lshl_add_u32 v206, v26, 4, v206
  s_lshl_b32 s3, s35, 6
  s_add_u32 s3, s3, 20971520
  v_add_u32 v206, s3, v206
  v_add_u32 v207, 14336, v206
  v_lshlrev_b32 v208, 4, v0
  v_add_u32 v208, 1835008, v208
  v_add_u32 v209, 8192, v208
  global_load_short_d16_hi v10, v1, s[4:5] nt
  global_load_short_d16_hi v11, v1, s[6:7] nt
  global_load_short_d16_hi v12, v1, s[8:9] nt
  global_load_short_d16_hi v13, v1, s[10:11] nt
  global_load_short_d16_hi v14, v1, s[12:13] nt
  global_load_short_d16_hi v15, v1, s[14:15] nt
  v_and_b32 v29, 15, v0
  v_bfe_u32 v27, v0, 4, 2
  v_bfe_u32 v28, v0, 4, 4
  v_min_u32 v28, 13, v28
  v_lshrrev_b32 v253, 5, v2
  v_and_b32 v254, 31, v2
  s_mov_b64 s[56:57], s[46:47]
  s_mov_b32 s59, 2560
  s_mov_b32 s60, 19
  s_mov_b32 s61, 458752
  s_cmp_eq_u32 s33, 2
  s_cselect_b64 s[56:57], s[52:53], s[56:57]
  s_cselect_b32 s59, 5376, s59
  s_cselect_b32 s60, 27, s60
  s_cselect_b32 s61, 1792, s61
  s_cmp_eq_u32 s33, 3
  s_cselect_b64 s[56:57], s[44:45], s[56:57]
  s_cselect_b32 s59, 768, s59
  s_cselect_b32 s60, 5, s60
  s_cselect_b32 s61, 114688, s61
  s_cmp_eq_u32 s33, 4
  s_cselect_b64 s[56:57], s[46:47], s[56:57]
  s_cselect_b32 s59, 768, s59
  s_cselect_b32 s60, 5, s60
  s_cselect_b32 s61, 114688, s61
  v_min_u32 v254, s60, v254
  v_lshl_add_u32 v253, s2, 1, v253
  v_mul_u32_u24 v253, s59, v253
  v_lshl_add_u32 v254, v254, 7, v253
  v_add_u32 v214, s61, v254
  s_cmp_lg_u32 s38, 0
  s_cbranch_scc1 F_hb
  s_mul_i32 s3, s2, 7168
  s_add_u32 s3, s3, 3584
  v_lshlrev_b32 v199, 6, v28
  v_lshl_add_u32 v199, v29, 2, v199
  v_add_u32 v199, s3, v199
  v_mul_u32_u24 v198, 114688, v28
  v_lshl_add_u32 v198, v29, 4, v198
  s_lshl_b32 s3, s2, 9
  s_add_u32 s3, s3, 10485760
  v_add_u32 v198, s3, v198
  s_lshr_b32 s29, s33, 1
  s_and_b32 s3, s33, 1
  v_and_b32 v216, 1, v29
  v_xor_b32 v216, 1, v216
  v_mul_u32_u24 v216, 1200, v216
  v_lshrrev_b32 v217, 1, v29
  v_lshlrev_b32 v217, 2, v217
  v_sub_u32 v216, v216, v217
  v_lshl_add_u32 v216, v27, 4, v216
  s_mul_i32 s24, s3, 3248
  s_add_u32 s25, s24, 119452
  v_add_u32 v216, s25, v216
  v_add_u32 v217, 512, v216
  v_lshlrev_b32 v219, 2, v27
  v_sub_u32 v219, v219, v29
  s_add_u32 s25, s24, 121804
  v_lshl_add_u32 v219, v219, 2, s25
  s_add_u32 s25, s24, 122576
  v_mov_b32 v222, s25
  v_lshlrev_b32 v220, 5, v29
  v_lshl_add_u32 v220, v27, 4, v220
  s_mul_i32 s24, s3, 4608
  s_add_u32 s24, s24, 110240
  v_add_u32 v220, s24, v220
  v_mul_u32_u24 v221, 320, v27
  v_lshl_add_u32 v221, v29, 4, v221
  s_mul_i32 s24, s3, 55104
  s_mul_i32 s25, s29, 10240
  s_add_u32 s24, s24, s25
  v_add_u32 v221, s24, v221
F_com:
  s_and_b32 s66, s2, 3
  s_lshl_b32 s66, s66, 2
  s_bfe_u32 s3, s2, 0x20003
  s_lshr_b32 s68, s2, 5
  s_add_u32 s66, s66, s3
  s_bfe_u32 s67, s2, 0x10002
  s_mul_i32 s69, s67, 7
  s_add_u32 s69, s69, s68
  s_lshl_b32 s70, s69, 2
  s_and_b32 s3, s33, 3
  s_add_u32 s70, s70, s3
  s_lshl_b32 s50, s3, 10
  s_lshl_b32 s3, s70, 6
  s_sub_u32 s3, 57344, s3
  s_sub_u32 s64, s64, s3
  s_subb_u32 s65, s65, 0
  s_lshl_b32 s32, s38, 13
  s_add_u32 s32, s32, 146560
  s_mul_i32 s59, s38, -8192
  s_add_u32 s59, s59, 146560
  s_add_u32 s61, s59, s50
  s_add_u32 s3, s32, s50
  v_lshrrev_b32 v223, 2, v2
  v_mul_u32_u24 v223, 3584, v223
  v_and_b32 v30, 3, v2
  v_lshl_add_u32 v223, v30, 4, v223
  s_add_u32 m0, s3, 0
  s_add_u32 s64, s64, 57344
  s_addc_u32 s65, s65, 0
  global_load_lds_dwordx4 v223, s[64:65]
  s_add_u32 m0, s3, 4096
  s_add_u32 s64, s64, 57344
  s_addc_u32 s65, s65, 0
  global_load_lds_dwordx4 v223, s[64:65]
  s_mov_b32 m0, s27
  v_lshrrev_b32 v27, 5, v2
  v_lshl_add_u32 v1, v27, 9, s50
  v_and_b32 v27, 13, v2
  v_lshl_add_u32 v1, v27, 4, v1
  v_and_b32 v27, 16, v2
  v_lshl_add_u32 v1, v27, 1, v1
  v_and_b32 v27, 2, v2
  v_lshl_add_u32 v1, v27, 2, v1
  v_add_u32 v18, 76928, v1
  v_and_b32 v27, 1, v0
  v_mul_u32_u24 v204, 7168, v27
  v_and_b32 v27, 2, v0
  v_lshl_add_u32 v204, v27, 2, v204
  s_lshl_b32 s3, s35, 4
  s_add_u32 s3, s3, 4096
  v_add_u32 v204, s3, v204
  v_bfe_u32 v27, v0, 2, 1
  v_mul_u32_u24 v27, 3584, v27
  v_add_u32 v204, v204, v27
  v_lshlrev_b32 v212, 3, v0
  v_add_u32 v212, 110208, v212
  v_mul_u32_u24 v213, 320, v26
  v_bfe_u32 v27, v0, 2, 4
  v_lshl_add_u32 v213, v27, 4, v213
  s_mul_i32 s3, s33, 1280
  v_add_u32 v213, s3, v213
  v_mov_b32 v27, 2160
  v_cmp_eq_u32 s[30:31], v27, v17
  s_mul_i32 s75, s38, 3248
  s_add_u32 s75, s75, 119424
  v_lshrrev_b32 v17, 1, v17
  v_add_u32 v17, s75, v17
  s_mov_b32 s14, 0x05040100
  s_mov_b32 s15, 0x07060302
  s_branch F_stats
F_hb:
  s_mov_b64 s[64:65], s[46:47]
  v_mov_b32 v199, 0
  v_mov_b32 v198, 0
  v_subrev_u32 v31, 256, v0
  v_lshlrev_b32 v220, 4, v31
  v_add_u32 v220, 1853184, v220
  v_lshlrev_b32 v222, 3, v31
  v_add_u32 v30, 162048, v222
  v_add_u32 v222, 75584, v222
  v_cmp_le_u32 vcc, 112, v31
  s_nop 1
  v_cndmask_b32 v222, v222, v30, vcc
  s_lshr_b32 s3, s35, 1
  s_lshl_b32 s3, s3, 4
  s_add_u32 s3, s3, 1851392
  v_mov_b32 v30, s3
  v_cmp_le_u32 vcc, 224, v31
  s_nop 1
  v_cndmask_b32 v220, v220, v30, vcc
  v_mov_b32 v30, 125920
  v_cndmask_b32 v222, v222, v30, vcc
  s_branch F_com
F_spare_loads:
  s_load_dword s40, s[20:21], 256
  s_sub_u32 s24, s2, 224
  s_min_u32 s25, s24, 27
  s_and_b32 s26, s25, 1
  s_lshr_b32 s25, s25, 1
  v_lshrrev_b32 v12, 3, v0
  v_min_u32 v12, 55, v12
  v_and_b32 v13, 7, v0
  s_mul_i32 s27, s26, 448
  v_lshl_add_u32 v10, v12, 3, s27
  v_mul_u32_u24 v14, 21504, v12
  v_lshl_add_u32 v14, v13, 4, v14
  s_mul_i32 s27, s26, 1204224
  s_lshl_b32 s28, s25, 7
  s_add_u32 s27, s27, s28
  v_add_u32 v14, s27, v14
  v_add_u32 v15, 5376, v14
  v_add_u32 v16, 10752, v14
  v_add_u32 v18, 16128, v14
  s_min_u32 s30, s24, 27
  s_sub_u32 s29, s30, s25
  s_lshl_b32 s29, s29, 7
  s_add_u32 s29, s29, 1792
  s_mul_i32 s31, s26, -2408448
  s_add_u32 s31, s31, 1204224
  v_lshlrev_b32 v40, 3, v12
  s_mul_i32 s27, s26, -448
  s_add_u32 s27, s27, 448
  v_add_u32 v40, s27, v40
  s_cmp_eq_u32 s33, 7
  s_cbranch_scc1 F_stats0
  global_load_dwordx2 v[10:11], v10, s[50:51]
  global_load_dwordx4 v[96:99], v14, s[52:53]
  global_load_dwordx4 v[100:103], v15, s[52:53]
  global_load_dwordx4 v[104:107], v16, s[52:53]
  global_load_dwordx4 v[108:111], v18, s[52:53]
  s_mov_b32 s27, 0xbfb8aa3b
  v_lshrrev_b32 v24, 5, v2
  v_lshlrev_b32 v24, 4, v24
  v_lshl_add_u32 v24, v13, 5, v24
  v_bfe_u32 v25, v2, 4, 1
  v_lshl_add_u32 v24, v25, 3, v24
  s_lshl_b32 s3, s33, 8
  v_add_u32 v24, s3, v24
  v_mov_b32 v198, 0
  v_mov_b32 v199, 0
  v_mov_b32 v204, 0
  v_mov_b32 v205, 0
  v_mov_b32 v206, 0
  v_mov_b32 v207, 0
  v_mov_b32 v208, 0
  v_mov_b32 v209, 0
  v_mov_b32 v210, 0
  v_mov_b32 v211, 0
  v_mov_b32 v212, 0
  v_mov_b32 v213, 0
  v_mov_b32 v214, 0
  v_mov_b32 v215, 0
  v_mov_b32 v216, 0
  v_mov_b32 v217, 0
  v_mov_b32 v218, 0
  v_mov_b32 v219, 0
  v_mov_b32 v220, 0
  v_mov_b32 v221, 0
  v_mov_b32 v222, 0
  v_mov_b32 v223, 0
  s_waitcnt vmcnt(5)
  s_branch F_stats
F_stats0:
  v_mov_b32 v198, 0
  v_mov_b32 v199, 0
  v_mov_b32 v204, 0
  v_mov_b32 v205, 0
  v_mov_b32 v206, 0
  v_mov_b32 v207, 0
  v_mov_b32 v208, 0
  v_mov_b32 v209, 0
  v_mov_b32 v210, 0
  v_mov_b32 v211, 0
  v_mov_b32 v212, 0
  v_mov_b32 v213, 0
  v_mov_b32 v214, 0
  v_mov_b32 v215, 0
  v_mov_b32 v216, 0
  v_mov_b32 v217, 0
  v_mov_b32 v218, 0
  v_mov_b32 v219, 0
  v_mov_b32 v220, 0
  v_mov_b32 v221, 0
  v_mov_b32 v222, 0
  v_mov_b32 v223, 0
  v_lshlrev_b32 v26, 2, v2
  s_mul_i32 s3, s26, 7168
  s_lshl_b32 s28, s25, 9
  s_add_u32 s3, s3, s28
  s_add_u32 s3, s3, 4096
  v_lshl_add_u32 v25, v2, 3, s3
  s_waitcnt vmcnt(0)
F_stats:
  s_mul_i32 s3, s33, 912
  s_add_u32 s3, s3, 115328
  v_add_u32 v8, s3, v3
  v_and_b32 v30, 3, v0
  v_mul_u32_u24 v28, 1824, v30
  v_and_b32 v29, 0x1fc, v0
  v_add3_u32 v28, v28, v29, s58
  v_add_u32 v31, 122624, v3
  s_mul_i32 s3, s2, 14336
  s_add_u32 s3, s3, 20971520
  v_lshl_add_u32 v29, v0, 4, s3
  v_add_u32 v27, 7168, v29
  s_lshr_b32 s3, s2, 1
  s_lshl_b32 s3, s3, 6
  s_and_b32 s60, s2, 1
  s_lshl_b32 s60, s60, 13
  s_add_u32 s3, s3, s60
  s_add_u32 s3, s3, 1835008
  v_add_u32 v9, s3, v3
  s_lshl_b32 s3, s33, 3
  s_add_u32 s3, s3, 122624
  v_mov_b32 v30, s3
  s_waitcnt vmcnt(8)
  v_dot2_f32_bf16 v42, v4, s42, 0
  v_dot2_f32_bf16 v43, v4, v4, 0
  s_mov_b32 exec_hi, 0x00ffffff
  ds_write_b128 v8, v[4:7]
  s_mov_b32 exec_hi, -1
  v_dot2_f32_bf16 v42, v5, s42, v42
  v_dot2_f32_bf16 v43, v5, v5, v43
  v_dot2_f32_bf16 v42, v6, s42, v42
  v_dot2_f32_bf16 v43, v6, v6, v43
  v_dot2_f32_bf16 v42, v7, s42, v42
  v_dot2_f32_bf16 v43, v7, v7, v43
  s_nop 2
  v_permlane32_swap_b32 v42, v43
  v_add_f32 v42, v42, v43
  s_nop 1
  v_add_f32_dpp v42, v42, v42 row_ror:8 row_mask:0xf bank_mask:0xf
  s_nop 1
  v_add_f32_dpp v42, v42, v42 row_ror:4 row_mask:0xf bank_mask:0xf
  s_nop 1
  v_add_f32_dpp v42, v42, v42 row_ror:2 row_mask:0xf bank_mask:0xf
  s_nop 1
  v_add_f32_dpp v42, v42, v42 row_ror:1 row_mask:0xf bank_mask:0xf
  v_mov_b32 v43, v42
  s_nop 1
  v_permlane16_swap_b32 v42, v43
  v_add_f32 v42, v42, v43
  v_mul_f32 v42, 0x3b124925, v42
  v_mov_b32 v43, v42
  s_nop 1
  v_permlane32_swap_b32 v42, v43
  v_fma_f32 v43, -v42, v42, v43
  v_max_f32 v43, 0, v43
  v_cvt_pk_bf16_f32 v43, v43, v43
  v_and_b32 v43, 0xffff0000, v43
  v_add_f32 v43, 0x3727c5ac, v43
  v_cvt_pk_bf16_f32 v43, v43, v43
  v_and_b32 v43, 0xffff0000, v43
  v_sqrt_f32 v43, v43
  s_waitcnt lgkmcnt(0)
  s_add_u32 s40, s40, 0x2f4a7c15
  v_mov_b32 v33, s40
  v_cvt_pk_bf16_f32 v32, v42, v43
  ds_write_b64 v30, v[32:33]
  s_or_b32 s73, s40, 0xffff0000
  v_mov_b32 v161, s73
  v_mov_b32 v163, s40
  v_mov_b32 v165, s73
  v_mov_b32 v167, s40
  s_cmp_ge_u32 s2, 224
  s_cbranch_scc1 F_b1
  s_bitcmp1_b32 0x1c, s33
  s_cbranch_scc0 F_mpr
  global_load_dword v214, v214, s[56:57]
F_mpr:
  s_lshl_b32 s3, s38, 4
  s_lshr_b32 s39, s39, s3
  s_lshl_b32 s39, s39, 16
  s_lshr_b32 s41, s41, s3
  s_lshl_b32 s41, s41, 16
  s_mov_b32 s29, 1069066811
  v_mov_b32 v16, s39
  v_mul_f32 v16, s29, v16
  v_exp_f32 v16, v16
  v_mov_b32 v215, s41
  v_cndmask_b32 v215, 0, v215, s[30:31]
  v_cvt_pk_bf16_f32 v16, v16, v16
  v_and_b32 v16, 0xffff0000, v16
  s_waitcnt vmcnt(2)
  v_mul_f32 v10, v16, v10
  v_mul_f32 v11, v16, v11
  v_mul_f32 v10, s29, v10
  v_mul_f32 v11, 0.15915494, v11
  v_mul_f32 v12, v16, v12
  v_mul_f32 v13, v16, v13
  v_mul_f32 v43, 0x41000000, v11
  v_mul_f32 v45, 0x43800000, v11
  v_mul_f32 v42, 0x41000000, v10
  v_mul_f32 v44, 0x43800000, v10
  v_fract_f32 v43, v43
  v_fract_f32 v41, v11
  v_fract_f32 v45, v45
  v_exp_f32 v42, v42
  v_cos_f32 v36, v43
  v_sin_f32 v37, v43
  v_exp_f32 v40, v10
  v_cos_f32 v34, v41
  v_sin_f32 v35, v41
  v_pk_mul_f32 v[36:37], v[36:37], v[42:43] op_sel_hi:[1,0]
  v_exp_f32 v44, v44
  v_cos_f32 v38, v45
  v_sin_f32 v39, v45
  v_pk_mul_f32 v[34:35], v[34:35], v[40:41] op_sel_hi:[1,0]
  v_mov_b32 v175, 0x3f80
  v_pk_mul_f32 v[38:39], v[38:39], v[44:45] op_sel_hi:[1,0]
F_b1:
  s_cmp_eq_u32 s33, 7
  s_waitcnt lgkmcnt(0)
  s_barrier
  s_cbranch_scc1 F_pub7
  ds_read_b32 v160, v28 offset:0
  ds_read_b32 v162, v28 offset:912
  ds_read_b32 v164, v28 offset:448
  ds_read_b32 v166, v28 offset:1360
  s_cmp_ge_u32 s2, 224
  s_waitcnt lgkmcnt(2)
  global_store_dwordx4 v29, v[160:163], s[20:21] sc1
  s_waitcnt lgkmcnt(0)
  global_store_dwordx4 v27, v[164:167], s[20:21] sc1
  s_cbranch_scc1 F_spare
  s_branch F_kg
F_pub7:
  s_cmp_ge_u32 s2, 224
  s_cbranch_scc1 F_spare7
  ds_read_b128 v[160:163], v31
  s_mov_b64 exec, 15
  s_waitcnt lgkmcnt(0)
  global_store_dwordx4 v9, v[160:163], s[20:21] sc1
  s_mov_b64 exec, -1
F_kg:
  s_cmp_lg_u32 s38, 0
  s_cbranch_scc1 F_on1
  global_load_dword v160, v199, s[48:49] offset:-3584 nt
  global_load_dword v161, v199, s[48:49] offset:-2688 nt
  global_load_dword v162, v199, s[48:49] offset:-1792 nt
  global_load_dword v163, v199, s[48:49] offset:-896 nt
  global_load_dword v164, v199, s[48:49] offset:0 nt
  global_load_dword v165, v199, s[48:49] offset:896 nt
  global_load_dword v166, v199, s[48:49] offset:1792 nt
  global_load_dword v167, v199, s[48:49] offset:2688 nt
F_on1:
  s_mov_b32 m0, s27
.p2align 3
  s_nop 0
  ds_write_addtid_b32 v175 offset:21840
  v_pk_mul_f32 v[48:49], v[14:15], v[12:13] op_sel_hi:[1,0]
  v_pk_mul_f32 v[100:101], v[36:37], v[36:37] op_sel_hi:[1,0]
  v_pk_fma_f32 v[48:49], v[14:15], v[12:13], v[48:49] op_sel:[1,1,0] op_sel_hi:[0,1,1] neg_lo:[1,0,0]
  v_pk_mul_f32 v[64:65], v[48:49], v[38:39] op_sel_hi:[1,0]
  v_cvt_pk_bf16_f32 v170, v36, v37
  v_pk_fma_f32 v[100:101], v[36:37], v[36:37], v[100:101] op_sel:[1,1,0] op_sel_hi:[0,1,1] neg_lo:[1,0,0]
  v_pk_mul_f32 v[50:51], v[48:49], v[34:35] op_sel_hi:[1,0]
  v_cvt_pk_bf16_f32 v171, v48, -v49
  v_pk_fma_f32 v[64:65], v[48:49], v[38:39], v[64:65] op_sel:[1,1,0] op_sel_hi:[0,1,1] neg_lo:[1,0,0]
  ds_write_addtid_b32 v170 offset:22880
  v_pk_mul_f32 v[102:103], v[100:101], v[36:37] op_sel_hi:[1,0]
  v_cvt_pk_bf16_f32 v172, v100, v101
  v_pk_fma_f32 v[50:51], v[48:49], v[34:35], v[50:51] op_sel:[1,1,0] op_sel_hi:[0,1,1] neg_lo:[1,0,0]
  ds_write_addtid_b32 v171 offset:0
  v_pk_mul_f32 v[72:73], v[64:65], v[38:39] op_sel_hi:[1,0]
  v_cvt_pk_bf16_f32 v173, v64, -v65
  v_pk_fma_f32 v[102:103], v[100:101], v[36:37], v[102:103] op_sel:[1,1,0] op_sel_hi:[0,1,1] neg_lo:[1,0,0]
  ds_write_addtid_b32 v172 offset:23920
  v_pk_mul_f32 v[52:53], v[50:51], v[34:35] op_sel_hi:[1,0]
  v_cvt_pk_bf16_f32 v174, v50, -v51
  v_pk_fma_f32 v[72:73], v[64:65], v[38:39], v[72:73] op_sel:[1,1,0] op_sel_hi:[0,1,1] neg_lo:[1,0,0]
  ds_write_addtid_b32 v173 offset:8320
  v_pk_mul_f32 v[104:105], v[100:101], v[100:101] op_sel_hi:[1,0]
  v_cvt_pk_bf16_f32 v168, v102, v103
  v_pk_fma_f32 v[52:53], v[50:51], v[34:35], v[52:53] op_sel:[1,1,0] op_sel_hi:[0,1,1] neg_lo:[1,0,0]
  ds_write_addtid_b32 v174 offset:1040
  v_pk_mul_f32 v[74:75], v[72:73], v[38:39] op_sel_hi:[1,0]
  v_cvt_pk_bf16_f32 v169, v72, -v73
  v_pk_fma_f32 v[104:105], v[100:101], v[100:101], v[104:105] op_sel:[1,1,0] op_sel_hi:[0,1,1] neg_lo:[1,0,0]
  ds_write_addtid_b32 v168 offset:24960
  v_pk_mul_f32 v[54:55], v[52:53], v[34:35] op_sel_hi:[1,0]
  v_cvt_pk_bf16_f32 v170, v52, -v53
  v_pk_fma_f32 v[74:75], v[72:73], v[38:39], v[74:75] op_sel:[1,1,0] op_sel_hi:[0,1,1] neg_lo:[1,0,0]
  ds_write_addtid_b32 v169 offset:12480
  v_pk_mul_f32 v[106:107], v[36:37], v[104:105] op_sel_hi:[1,0]
  v_cvt_pk_bf16_f32 v171, v104, v105
  v_pk_fma_f32 v[54:55], v[52:53], v[34:35], v[54:55] op_sel:[1,1,0] op_sel_hi:[0,1,1] neg_lo:[1,0,0]
  ds_write_addtid_b32 v170 offset:2080
  v_pk_mul_f32 v[80:81], v[74:75], v[38:39] op_sel_hi:[1,0]
  v_cvt_pk_bf16_f32 v172, v74, -v75
  v_pk_fma_f32 v[106:107], v[36:37], v[104:105], v[106:107] op_sel:[1,1,0] op_sel_hi:[0,1,1] neg_lo:[1,0,0]
  ds_write_addtid_b32 v171 offset:26000
  v_pk_mul_f32 v[56:57], v[54:55], v[34:35] op_sel_hi:[1,0]
  v_cvt_pk_bf16_f32 v173, v54, -v55
  v_pk_fma_f32 v[80:81], v[74:75], v[38:39], v[80:81] op_sel:[1,1,0] op_sel_hi:[0,1,1] neg_lo:[1,0,0]
  ds_write_addtid_b32 v172 offset:13520
  v_pk_mul_f32 v[108:109], v[100:101], v[104:105] op_sel_hi:[1,0]
  v_cvt_pk_bf16_f32 v174, v106, v107
  v_pk_fma_f32 v[56:57], v[54:55], v[34:35], v[56:57] op_sel:[1,1,0] op_sel_hi:[0,1,1] neg_lo:[1,0,0]
  ds_write_addtid_b32 v173 offset:3120
  v_pk_mul_f32 v[82:83], v[80:81], v[38:39] op_sel_hi:[1,0]
  v_cvt_pk_bf16_f32 v168, v80, -v81
  v_pk_fma_f32 v[108:109], v[100:101], v[104:105], v[108:109] op_sel:[1,1,0] op_sel_hi:[0,1,1] neg_lo:[1,0,0]
  ds_write_addtid_b32 v174 offset:27040
  v_pk_mul_f32 v[110:111], v[102:103], v[104:105] op_sel_hi:[1,0]
  v_cvt_pk_bf16_f32 v169, v56, -v57
  v_pk_fma_f32 v[82:83], v[80:81], v[38:39], v[82:83] op_sel:[1,1,0] op_sel_hi:[0,1,1] neg_lo:[1,0,0]
  ds_write_addtid_b32 v168 offset:16640
  v_pk_mul_f32 v[112:113], v[104:105], v[104:105] op_sel_hi:[1,0]
  v_cvt_pk_bf16_f32 v170, v108, v109
  v_pk_fma_f32 v[110:111], v[102:103], v[104:105], v[110:111] op_sel:[1,1,0] op_sel_hi:[0,1,1] neg_lo:[1,0,0]
  ds_write_addtid_b32 v169 offset:4160
  v_pk_mul_f32 v[58:59], v[56:57], v[34:35] op_sel_hi:[1,0]
  v_cvt_pk_bf16_f32 v171, v82, -v83
  v_pk_fma_f32 v[112:113], v[104:105], v[104:105], v[112:113] op_sel:[1,1,0] op_sel_hi:[0,1,1] neg_lo:[1,0,0]
  ds_write_addtid_b32 v170 offset:28080
  v_pk_mul_f32 v[68:69], v[56:57], v[38:39] op_sel_hi:[1,0]
  v_cvt_pk_bf16_f32 v172, v110, v111
  v_pk_fma_f32 v[58:59], v[56:57], v[34:35], v[58:59] op_sel:[1,1,0] op_sel_hi:[0,1,1] neg_lo:[1,0,0]
  ds_write_addtid_b32 v171 offset:17680
  v_pk_mul_f32 v[84:85], v[82:83], v[38:39] op_sel_hi:[1,0]
  v_cvt_pk_bf16_f32 v173, v112, v113
  v_pk_fma_f32 v[68:69], v[56:57], v[38:39], v[68:69] op_sel:[1,1,0] op_sel_hi:[0,1,1] neg_lo:[1,0,0]
  ds_write_addtid_b32 v172 offset:29120
  v_pk_mul_f32 v[114:115], v[36:37], v[112:113] op_sel_hi:[1,0]
  v_cvt_pk_bf16_f32 v174, v58, -v59
  v_pk_fma_f32 v[84:85], v[82:83], v[38:39], v[84:85] op_sel:[1,1,0] op_sel_hi:[0,1,1] neg_lo:[1,0,0]
  ds_write_addtid_b32 v173 offset:30160
  v_pk_mul_f32 v[116:117], v[100:101], v[112:113] op_sel_hi:[1,0]
  v_cvt_pk_bf16_f32 v168, v68, -v69
  v_pk_fma_f32 v[114:115], v[36:37], v[112:113], v[114:115] op_sel:[1,1,0] op_sel_hi:[0,1,1] neg_lo:[1,0,0]
  ds_write_addtid_b32 v174 offset:5200
  v_pk_mul_f32 v[118:119], v[102:103], v[112:113] op_sel_hi:[1,0]
  v_cvt_pk_bf16_f32 v169, v84, -v85
  v_pk_fma_f32 v[116:117], v[100:101], v[112:113], v[116:117] op_sel:[1,1,0] op_sel_hi:[0,1,1] neg_lo:[1,0,0]
  ds_write_addtid_b32 v168 offset:10400
  v_pk_mul_f32 v[120:121], v[104:105], v[112:113] op_sel_hi:[1,0]
  v_cvt_pk_bf16_f32 v170, v114, v115
  v_pk_fma_f32 v[118:119], v[102:103], v[112:113], v[118:119] op_sel:[1,1,0] op_sel_hi:[0,1,1] neg_lo:[1,0,0]
  ds_write_addtid_b32 v169 offset:18720
  v_pk_mul_f32 v[122:123], v[106:107], v[112:113] op_sel_hi:[1,0]
  v_cvt_pk_bf16_f32 v171, v116, v117
  v_pk_fma_f32 v[120:121], v[104:105], v[112:113], v[120:121] op_sel:[1,1,0] op_sel_hi:[0,1,1] neg_lo:[1,0,0]
  ds_write_addtid_b32 v170 offset:31200
  v_pk_mul_f32 v[124:125], v[108:109], v[112:113] op_sel_hi:[1,0]
  v_cvt_pk_bf16_f32 v172, v118, v119
  v_pk_fma_f32 v[122:123], v[106:107], v[112:113], v[122:123] op_sel:[1,1,0] op_sel_hi:[0,1,1] neg_lo:[1,0,0]
  ds_write_addtid_b32 v171 offset:32240
  v_pk_mul_f32 v[126:127], v[110:111], v[112:113] op_sel_hi:[1,0]
  v_cvt_pk_bf16_f32 v173, v120, v121
  v_pk_fma_f32 v[124:125], v[108:109], v[112:113], v[124:125] op_sel:[1,1,0] op_sel_hi:[0,1,1] neg_lo:[1,0,0]
  ds_write_addtid_b32 v172 offset:33280
  s_bitcmp1_b32 0x2, s33
  s_cbranch_scc0 F_mp30
  global_load_dword v214, v214, s[56:57]
F_mp30:
  v_pk_mul_f32 v[60:61], v[58:59], v[34:35] op_sel_hi:[1,0]
  v_cvt_pk_bf16_f32 v174, v122, v123
  v_pk_fma_f32 v[126:127], v[110:111], v[112:113], v[126:127] op_sel:[1,1,0] op_sel_hi:[0,1,1] neg_lo:[1,0,0]
  ds_write_addtid_b32 v173 offset:34320
  v_pk_mul_f32 v[76:77], v[68:69], v[38:39] op_sel_hi:[1,0]
  v_cvt_pk_bf16_f32 v168, v124, v125
  v_pk_fma_f32 v[60:61], v[58:59], v[34:35], v[60:61] op_sel:[1,1,0] op_sel_hi:[0,1,1] neg_lo:[1,0,0]
  ds_write_addtid_b32 v174 offset:35360
  v_pk_mul_f32 v[86:87], v[84:85], v[38:39] op_sel_hi:[1,0]
  v_cvt_pk_bf16_f32 v169, v126, v127
  v_pk_fma_f32 v[76:77], v[68:69], v[38:39], v[76:77] op_sel:[1,1,0] op_sel_hi:[0,1,1] neg_lo:[1,0,0]
  ds_write_addtid_b32 v168 offset:36400
  v_pk_mul_f32 v[128:129], v[112:113], v[112:113] op_sel_hi:[1,0]
  v_cvt_pk_bf16_f32 v170, v60, -v61
  v_pk_fma_f32 v[86:87], v[84:85], v[38:39], v[86:87] op_sel:[1,1,0] op_sel_hi:[0,1,1] neg_lo:[1,0,0]
  ds_write_addtid_b32 v169 offset:37440
  v_pk_mul_f32 v[130:131], v[114:115], v[112:113] op_sel_hi:[1,0]
  v_cvt_pk_bf16_f32 v171, v76, -v77
  v_pk_fma_f32 v[128:129], v[112:113], v[112:113], v[128:129] op_sel:[1,1,0] op_sel_hi:[0,1,1] neg_lo:[1,0,0]
  ds_write_addtid_b32 v170 offset:6240
  v_pk_mul_f32 v[132:133], v[116:117], v[112:113] op_sel_hi:[1,0]
  v_cvt_pk_bf16_f32 v172, v86, -v87
  v_pk_fma_f32 v[130:131], v[114:115], v[112:113], v[130:131] op_sel:[1,1,0] op_sel_hi:[0,1,1] neg_lo:[1,0,0]
  ds_write_addtid_b32 v171 offset:14560
  v_pk_mul_f32 v[134:135], v[118:119], v[112:113] op_sel_hi:[1,0]
  v_cvt_pk_bf16_f32 v173, v128, v129
  v_pk_fma_f32 v[132:133], v[116:117], v[112:113], v[132:133] op_sel:[1,1,0] op_sel_hi:[0,1,1] neg_lo:[1,0,0]
  ds_write_addtid_b32 v172 offset:19760
  v_pk_mul_f32 v[136:137], v[120:121], v[112:113] op_sel_hi:[1,0]
  v_cvt_pk_bf16_f32 v174, v130, v131
  v_pk_fma_f32 v[134:135], v[118:119], v[112:113], v[134:135] op_sel:[1,1,0] op_sel_hi:[0,1,1] neg_lo:[1,0,0]
  ds_write_addtid_b32 v173 offset:38480
  v_pk_mul_f32 v[138:139], v[122:123], v[112:113] op_sel_hi:[1,0]
  v_cvt_pk_bf16_f32 v168, v132, v133
  v_pk_fma_f32 v[136:137], v[120:121], v[112:113], v[136:137] op_sel:[1,1,0] op_sel_hi:[0,1,1] neg_lo:[1,0,0]
  ds_write_addtid_b32 v174 offset:39520
  v_pk_mul_f32 v[140:141], v[124:125], v[112:113] op_sel_hi:[1,0]
  v_cvt_pk_bf16_f32 v169, v134, v135
  v_pk_fma_f32 v[138:139], v[122:123], v[112:113], v[138:139] op_sel:[1,1,0] op_sel_hi:[0,1,1] neg_lo:[1,0,0]
  ds_write_addtid_b32 v168 offset:40560
  v_pk_mul_f32 v[142:143], v[126:127], v[112:113] op_sel_hi:[1,0]
  v_cvt_pk_bf16_f32 v170, v136, v137
  v_pk_fma_f32 v[140:141], v[124:125], v[112:113], v[140:141] op_sel:[1,1,0] op_sel_hi:[0,1,1] neg_lo:[1,0,0]
  ds_write_addtid_b32 v169 offset:41600
  v_pk_mul_f32 v[62:63], v[60:61], v[34:35] op_sel_hi:[1,0]
  v_cvt_pk_bf16_f32 v171, v138, v139
  v_pk_fma_f32 v[142:143], v[126:127], v[112:113], v[142:143] op_sel:[1,1,0] op_sel_hi:[0,1,1] neg_lo:[1,0,0]
  ds_write_addtid_b32 v170 offset:42640
  v_pk_mul_f32 v[66:67], v[52:53], v[38:39] op_sel_hi:[1,0]
  v_cvt_pk_bf16_f32 v172, v140, v141
  v_pk_fma_f32 v[62:63], v[60:61], v[34:35], v[62:63] op_sel:[1,1,0] op_sel_hi:[0,1,1] neg_lo:[1,0,0]
  ds_write_addtid_b32 v171 offset:43680
  v_pk_mul_f32 v[70:71], v[60:61], v[38:39] op_sel_hi:[1,0]
  v_cvt_pk_bf16_f32 v173, v142, v143
  v_pk_fma_f32 v[66:67], v[52:53], v[38:39], v[66:67] op_sel:[1,1,0] op_sel_hi:[0,1,1] neg_lo:[1,0,0]
  ds_write_addtid_b32 v172 offset:44720
  v_pk_mul_f32 v[78:79], v[76:77], v[38:39] op_sel_hi:[1,0]
  v_cvt_pk_bf16_f32 v174, v62, -v63
  v_pk_fma_f32 v[70:71], v[60:61], v[38:39], v[70:71] op_sel:[1,1,0] op_sel_hi:[0,1,1] neg_lo:[1,0,0]
  ds_write_addtid_b32 v173 offset:45760
  v_pk_mul_f32 v[88:89], v[86:87], v[38:39] op_sel_hi:[1,0]
  v_cvt_pk_bf16_f32 v168, v66, -v67
  v_pk_fma_f32 v[78:79], v[76:77], v[38:39], v[78:79] op_sel:[1,1,0] op_sel_hi:[0,1,1] neg_lo:[1,0,0]
  ds_write_addtid_b32 v174 offset:7280
  v_pk_mul_f32 v[144:145], v[128:129], v[112:113] op_sel_hi:[1,0]
  v_cvt_pk_bf16_f32 v169, v70, -v71
  v_pk_fma_f32 v[88:89], v[86:87], v[38:39], v[88:89] op_sel:[1,1,0] op_sel_hi:[0,1,1] neg_lo:[1,0,0]
  ds_write_addtid_b32 v168 offset:9360
  v_pk_mul_f32 v[146:147], v[130:131], v[112:113] op_sel_hi:[1,0]
  v_cvt_pk_bf16_f32 v170, v78, -v79
  v_pk_fma_f32 v[144:145], v[128:129], v[112:113], v[144:145] op_sel:[1,1,0] op_sel_hi:[0,1,1] neg_lo:[1,0,0]
  ds_write_addtid_b32 v169 offset:11440
  v_pk_mul_f32 v[148:149], v[132:133], v[112:113] op_sel_hi:[1,0]
  v_cvt_pk_bf16_f32 v171, v88, -v89
  v_pk_fma_f32 v[146:147], v[130:131], v[112:113], v[146:147] op_sel:[1,1,0] op_sel_hi:[0,1,1] neg_lo:[1,0,0]
  ds_write_addtid_b32 v170 offset:15600
  v_pk_mul_f32 v[150:151], v[134:135], v[112:113] op_sel_hi:[1,0]
  v_cvt_pk_bf16_f32 v172, v144, v145
  v_pk_fma_f32 v[148:149], v[132:133], v[112:113], v[148:149] op_sel:[1,1,0] op_sel_hi:[0,1,1] neg_lo:[1,0,0]
  ds_write_addtid_b32 v171 offset:20800
  v_pk_mul_f32 v[152:153], v[136:137], v[112:113] op_sel_hi:[1,0]
  v_cvt_pk_bf16_f32 v173, v146, v147
  v_pk_fma_f32 v[150:151], v[134:135], v[112:113], v[150:151] op_sel:[1,1,0] op_sel_hi:[0,1,1] neg_lo:[1,0,0]
  ds_write_addtid_b32 v172 offset:46800
  v_pk_mul_f32 v[154:155], v[138:139], v[112:113] op_sel_hi:[1,0]
  v_cvt_pk_bf16_f32 v174, v148, v149
  v_pk_fma_f32 v[152:153], v[136:137], v[112:113], v[152:153] op_sel:[1,1,0] op_sel_hi:[0,1,1] neg_lo:[1,0,0]
  ds_write_addtid_b32 v173 offset:47840
  v_pk_mul_f32 v[156:157], v[140:141], v[112:113] op_sel_hi:[1,0]
  v_cvt_pk_bf16_f32 v168, v150, v151
  v_pk_fma_f32 v[154:155], v[138:139], v[112:113], v[154:155] op_sel:[1,1,0] op_sel_hi:[0,1,1] neg_lo:[1,0,0]
  ds_write_addtid_b32 v174 offset:48880
  v_pk_mul_f32 v[158:159], v[142:143], v[112:113] op_sel_hi:[1,0]
  v_cvt_pk_bf16_f32 v169, v152, v153
  v_pk_fma_f32 v[156:157], v[140:141], v[112:113], v[156:157] op_sel:[1,1,0] op_sel_hi:[0,1,1] neg_lo:[1,0,0]
  ds_write_addtid_b32 v168 offset:49920
  v_cvt_pk_bf16_f32 v170, v154, v155
  v_pk_fma_f32 v[158:159], v[142:143], v[112:113], v[158:159] op_sel:[1,1,0] op_sel_hi:[0,1,1] neg_lo:[1,0,0]
  ds_write_addtid_b32 v169 offset:50960
  v_cvt_pk_bf16_f32 v171, v156, v157
  ds_write_addtid_b32 v170 offset:52000
  v_cvt_pk_bf16_f32 v172, v158, v159
  ds_write_addtid_b32 v171 offset:53040
  ds_write_addtid_b32 v172 offset:54080
  ds_read_b128 v[48:51], v210 offset:0
  ds_read_b128 v[96:99], v210 offset:21840
  ds_read_b128 v[52:55], v210 offset:32
  ds_read_b128 v[100:103], v210 offset:21872
  ds_read_b128 v[56:59], v210 offset:64
  ds_read_b128 v[104:107], v210 offset:21904
  ds_read_b128 v[60:63], v210 offset:96
  ds_read_b128 v[108:111], v210 offset:21936
  ds_read_b128 v[64:67], v210 offset:128
  ds_read_b128 v[112:115], v210 offset:21968
  ds_read_b128 v[68:71], v210 offset:160
  ds_read_b128 v[116:119], v210 offset:22000
  ds_read_b128 v[72:75], v210 offset:192
  ds_read_b128 v[120:123], v210 offset:22032
  ds_read_b128 v[76:79], v210 offset:224
  ds_read_b128 v[124:127], v210 offset:22064
  s_and_b32 s3, s33, 6
  s_cbranch_scc1 F_nm
  v_add_u32 v19, 6144, v3
  global_load_dwordx4 v[128:131], v19, s[22:23] offset:-2048
  global_load_dwordx4 v[132:135], v19, s[22:23] offset:-1024
  global_load_dwordx4 v[136:139], v19, s[22:23] offset:0
  global_load_dwordx4 v[140:143], v19, s[22:23] offset:1024
  global_load_dwordx4 v[144:147], v19, s[22:23] offset:2048
F_nm:
  v_mov_b32 v30, 0
  s_waitcnt lgkmcnt(14)
  v_mfma_f32_32x32x16_bf16 v[80:95], v[48:51], v[96:99], 0
  v_and_b32 v24, 0xffff, v20
  v_add_u32 v24, s28, v24
  s_waitcnt lgkmcnt(12)
  v_mfma_f32_32x32x16_bf16 v[80:95], v[52:55], v[100:103], v[80:95]
  v_lshrrev_b32 v25, 16, v20
  v_add_u32 v25, s28, v25
  s_waitcnt lgkmcnt(10)
  v_mfma_f32_32x32x16_bf16 v[80:95], v[56:59], v[104:107], v[80:95]
  v_and_b32 v26, 0xffff, v21
  v_add_u32 v26, s28, v26
  s_waitcnt lgkmcnt(8)
  v_mfma_f32_32x32x16_bf16 v[80:95], v[60:63], v[108:111], v[80:95]
  v_lshrrev_b32 v27, 16, v21
  v_add_u32 v27, s28, v27
  s_waitcnt lgkmcnt(6)
  v_mfma_f32_32x32x16_bf16 v[80:95], v[64:67], v[112:115], v[80:95]
  v_and_b32 v28, 0xffff, v22
  v_add_u32 v28, s28, v28
  s_waitcnt lgkmcnt(4)
  v_mfma_f32_32x32x16_bf16 v[80:95], v[68:71], v[116:119], v[80:95]
  v_lshrrev_b32 v29, 16, v22
  v_add_u32 v29, s75, v29
  s_waitcnt lgkmcnt(2)
  v_mfma_f32_32x32x16_bf16 v[80:95], v[72:75], v[120:123], v[80:95]
  s_waitcnt lgkmcnt(0)
  v_mfma_f32_32x32x16_bf16 v[80:95], v[76:79], v[124:127], v[80:95]
  ds_write_b32 v211, v30 offset:128
  s_nop 10
  ds_write_b32 v211, v80 offset:0
  ds_write_b32 v211, v81 offset:1040
  ds_write_b32 v211, v82 offset:2080
  ds_write_b32 v211, v83 offset:3120
  ds_write_b32 v211, v84 offset:8320
  ds_write_b32 v211, v85 offset:9360
  ds_write_b32 v211, v86 offset:10400
  ds_write_b32 v211, v87 offset:11440
  ds_write_b32 v211, v88 offset:16640
  s_mov_b32 exec_hi, 0
  ds_write_b32 v211, v89 offset:17680
  ds_write_b32 v211, v90 offset:18720
  ds_write_b32 v211, v91 offset:19760
  s_mov_b32 exec_hi, -1
  v_add_u32 v20, 138368, v1
  s_cmp_lg_u32 s38, 0
  s_cbranch_scc1 F_on2
  s_waitcnt vmcnt(8)
  ds_read_b64_tr_b16 v[224:225], v20 offset:8192
  ds_read_b64_tr_b16 v[226:227], v20 offset:8448
  ds_read_b64_tr_b16 v[228:229], v20 offset:12288
  ds_read_b64_tr_b16 v[230:231], v20 offset:12544
F_on2:
  global_load_dwordx4 v[176:179], v206, s[20:21] sc1
  global_load_dwordx4 v[180:183], v207, s[20:21] sc1
  global_load_dwordx4 v[184:187], v208, s[20:21] sc1
  global_load_dwordx4 v[188:191], v209, s[20:21] sc1
  s_waitcnt lgkmcnt(0)
  s_barrier
  ds_read2st64_b32 v[48:49], v24 offset0:0 offset1:1
  ds_read2st64_b32 v[50:51], v24 offset0:2 offset1:3
  ds_read2st64_b32 v[52:53], v25 offset0:0 offset1:1
  ds_read2st64_b32 v[54:55], v25 offset0:2 offset1:3
  ds_read2st64_b32 v[56:57], v26 offset0:0 offset1:1
  ds_read2st64_b32 v[58:59], v26 offset0:2 offset1:3
  ds_read2st64_b32 v[60:61], v27 offset0:0 offset1:1
  ds_read2st64_b32 v[62:63], v27 offset0:2 offset1:3
  ds_read2st64_b32 v[64:65], v28 offset0:0 offset1:1
  ds_read2st64_b32 v[66:67], v28 offset0:2 offset1:3
  global_load_dwordx2 v[192:193], v204, s[20:21] sc1
  s_cmp_lg_u32 s38, 0
  s_cbranch_scc1 F_on3
  s_add_u32 m0, s50, 138368
  s_add_u32 s64, s64, 57344
  s_addc_u32 s65, s65, 0
  global_load_lds_dwordx4 v223, s[64:65]
  s_add_u32 m0, s50, 142464
  s_add_u32 s64, s64, 57344
  s_addc_u32 s65, s65, 0
  global_load_lds_dwordx4 v223, s[64:65]
F_on3:
  s_waitcnt lgkmcnt(8)
  v_pk_add_f32 v[48:49], v[48:49], v[50:51]
  v_add_f32 v48, v48, v49
  s_cmp_lg_u32 s38, 0
  s_cbranch_scc1 F_on4
  s_add_u32 m0, s50, 134272
  s_add_u32 s64, s64, 57344
  s_addc_u32 s65, s65, 0
  global_load_lds_dwordx4 v223, s[64:65]
  s_add_u32 m0, s50, 130176
  s_add_u32 s64, s64, 57344
  s_addc_u32 s65, s65, 0
  global_load_lds_dwordx4 v223, s[64:65]
F_on4:
  s_waitcnt lgkmcnt(6)
  v_pk_add_f32 v[52:53], v[52:53], v[54:55]
  v_add_f32 v52, v52, v53
  v_cvt_pk_bf16_f32 v88, v48, v52
  s_cmp_lg_u32 s38, 0
  s_cbranch_scc1 F_on5
  s_add_u32 m0, s50, 126080
  s_add_u32 s64, s64, 57344
  s_addc_u32 s65, s65, 0
  global_load_lds_dwordx4 v223, s[64:65]
  s_add_u32 m0, s50, 146560
  s_add_u32 s64, s64, 57344
  s_addc_u32 s65, s65, 0
  global_load_lds_dwordx4 v223, s[64:65]
F_on5:
  s_waitcnt lgkmcnt(4)
  v_pk_add_f32 v[56:57], v[56:57], v[58:59]
  v_add_f32 v56, v56, v57
  v_cvt_pk_bf16_f32 v92, v52, v56
  s_waitcnt lgkmcnt(2)
  v_pk_add_f32 v[60:61], v[60:61], v[62:63]
  v_add_f32 v60, v60, v215
  v_add_f32 v60, v60, v61
  v_cvt_pk_bf16_f32 v89, v56, v60
  s_waitcnt lgkmcnt(0)
  v_pk_add_f32 v[64:65], v[64:65], v[66:67]
  v_add_f32 v64, v64, v65
  v_cvt_pk_bf16_f32 v93, v60, v64
  ds_write_b64 v17, v[92:93] offset:1200
  ds_write_b64 v29, v[88:89]
  s_waitcnt vmcnt(7)
  s_cmp_lg_u32 s38, 1
  s_cbranch_scc1 F_on6
  s_waitcnt vmcnt(1)
F_on6:
F_chk:
  v_xor_b32 v10, s73, v177
  v_xor_b32 v11, s40, v179
  v_xor_b32 v12, s73, v181
  v_xor_b32 v13, s40, v183
  v_or3_b32 v10, v10, v11, v12
  v_xor_b32 v11, s40, v185
  v_xor_b32 v12, s40, v187
  v_or3_b32 v10, v10, v11, v12
  v_xor_b32 v11, s40, v189
  v_xor_b32 v12, s40, v191
  v_or3_b32 v13, v13, v11, v12
  v_or_b32 v10, v10, v13
  v_cmp_ne_u32 vcc, 0, v10
  s_cbranch_vccnz F_rt1
F_ok:
  s_mov_b64 exec, -1
  s_cmp_lg_u32 s38, 1
  s_cbranch_scc1 F_on7
  s_add_u32 m0, s50, 21824
  s_add_u32 s64, s64, 57344
  s_addc_u32 s65, s65, 0
  global_load_lds_dwordx4 v223, s[64:65]
  s_add_u32 m0, s50, 25920
  s_add_u32 s64, s64, 57344
  s_addc_u32 s65, s65, 0
  global_load_lds_dwordx4 v223, s[64:65]
  s_add_u32 m0, s50, 30016
  s_add_u32 s64, s64, 57344
  s_addc_u32 s65, s65, 0
  global_load_lds_dwordx4 v223, s[64:65]
  s_add_u32 m0, s50, 34112
  s_add_u32 s64, s64, 57344
  s_addc_u32 s65, s65, 0
  global_load_lds_dwordx4 v223, s[64:65]
  s_add_u32 m0, s50, 38208
  s_add_u32 s64, s64, 57344
  s_addc_u32 s65, s65, 0
  global_load_lds_dwordx4 v223, s[64:65]
  s_add_u32 m0, s50, 42304
  s_add_u32 s64, s64, 57344
  s_addc_u32 s65, s65, 0
  global_load_lds_dwordx4 v223, s[64:65]
F_on7:
  v_and_b32 v49, 0xffff0000, v184
  v_and_b32 v51, 0xffff0000, v186
  v_and_b32 v53, 0xffff0000, v188
  v_and_b32 v55, 0xffff0000, v190
  v_rcp_f32 v49, v49
  v_rcp_f32 v51, v51
  v_rcp_f32 v53, v53
  v_rcp_f32 v55, v55
  v_lshlrev_b32 v48, 16, v184
  v_lshlrev_b32 v50, 16, v186
  v_lshlrev_b32 v52, 16, v188
  v_lshlrev_b32 v54, 16, v190
  v_lshlrev_b32 v32, 16, v176
  v_and_b32 v33, 0xffff0000, v176
  v_lshlrev_b32 v34, 16, v178
  v_and_b32 v35, 0xffff0000, v178
  v_lshlrev_b32 v36, 16, v180
  v_and_b32 v37, 0xffff0000, v180
  v_lshlrev_b32 v38, 16, v182
  v_and_b32 v39, 0xffff0000, v182
  v_pk_add_f32 v[56:57], v[32:33], v[48:49] op_sel_hi:[1,0] neg_lo:[0,1] neg_hi:[0,1]
  v_pk_add_f32 v[58:59], v[34:35], v[50:51] op_sel_hi:[1,0] neg_lo:[0,1] neg_hi:[0,1]
  v_pk_add_f32 v[60:61], v[36:37], v[52:53] op_sel_hi:[1,0] neg_lo:[0,1] neg_hi:[0,1]
  v_pk_add_f32 v[62:63], v[38:39], v[54:55] op_sel_hi:[1,0] neg_lo:[0,1] neg_hi:[0,1]
  v_pk_mul_f32 v[56:57], v[48:49], v[56:57] op_sel:[1,0]
  v_pk_mul_f32 v[58:59], v[50:51], v[58:59] op_sel:[1,0]
  v_pk_mul_f32 v[60:61], v[52:53], v[60:61] op_sel:[1,0]
  v_pk_mul_f32 v[62:63], v[54:55], v[62:63] op_sel:[1,0]
  s_waitcnt vmcnt(6)
F_chkm:
  v_cmp_ne_u32 vcc, s40, v193
  v_add_f32_dpp v10, v192, v192 quad_perm:[1,0,3,2] row_mask:0xf bank_mask:0xf
  s_cbranch_vccnz F_rt2
F_okm:
  v_cvt_pk_bf16_f32 v10, v10, v10
  v_and_b32 v10, 0xffff0000, v10
  v_add_f32 v11, 1.0, v10
  v_cvt_pk_bf16_f32 v11, v11, v11
  v_readlane_b32 s30, v10, 0
  v_readlane_b32 s31, v10, 2
  v_and_b32 v11, 0xffff0000, v11
  v_mov_b32 v12, s30
  v_readlane_b32 s54, v11, 4
  v_readlane_b32 s55, v11, 6
  v_mov_b32 v13, s31
  s_cmp_lg_u32 s38, 0
  v_pk_fma_f32 v[56:57], v[56:57], s[54:55], v[12:13]
  v_pk_fma_f32 v[58:59], v[58:59], s[54:55], v[12:13]
  v_pk_fma_f32 v[60:61], v[60:61], s[54:55], v[12:13]
  v_pk_fma_f32 v[62:63], v[62:63], s[54:55], v[12:13]
  v_cvt_pk_bf16_f32 v64, v56, v58
  v_cvt_pk_bf16_f32 v65, v60, v62
  ds_write_b64 v212, v[64:65] offset:512
  v_cvt_pk_bf16_f32 v66, v57, v59
  v_cvt_pk_bf16_f32 v67, v61, v63
  ds_write_b64 v212, v[66:67] offset:5120
  s_cbranch_scc1 F_prep
  s_waitcnt vmcnt(0)
  ds_read_b64_tr_b16 v[232:233], v20 offset:0
  ds_read_b64_tr_b16 v[234:235], v20 offset:256
  ds_read_b64_tr_b16 v[236:237], v20 offset:4096
  ds_read_b64_tr_b16 v[238:239], v20 offset:4352
  ds_read_b64_tr_b16 v[240:241], v18 offset:57344
  ds_read_b64_tr_b16 v[242:243], v18 offset:57600
  ds_read_b64_tr_b16 v[244:245], v18 offset:53248
  ds_read_b64_tr_b16 v[246:247], v18 offset:53504
  ds_read_b64_tr_b16 v[248:249], v18 offset:49152
  ds_read_b64_tr_b16 v[250:251], v18 offset:49408
  ds_read_b64_tr_b16 v[252:253], v20 offset:8192
  ds_read_b64_tr_b16 v[254:255], v20 offset:8448
  v_perm_b32 v48, v161, v160, s14
  v_perm_b32 v49, v163, v162, s14
  v_perm_b32 v50, v165, v164, s14
  v_perm_b32 v51, v167, v166, s14
  global_store_dwordx4 v198, v[48:51], s[20:21] offset:0 sc1
  v_perm_b32 v52, v161, v160, s15
  v_perm_b32 v53, v163, v162, s15
  v_perm_b32 v54, v165, v164, s15
  v_perm_b32 v55, v167, v166, s15
  global_store_dwordx4 v198, v[52:55], s[20:21] offset:256 sc1
  s_setprio 3
  s_bitcmp1_b32 s33, 1
  s_cbranch_scc1 F_cv1
  s_waitcnt lgkmcnt(0)
  s_barrier
  ds_read2_b32 v[108:109], v217 offset0:128 offset1:129
  ds_read2_b32 v[110:111], v217 offset0:130 offset1:131
  ds_read_b128 v[76:79], v220 offset:448
  ds_read_b128 v[80:83], v220 offset:960
  ds_read_b128 v[84:87], v220 offset:1472
  ds_read_b128 v[88:91], v220 offset:1984
  ds_read_b128 v[92:95], v220 offset:2496
  ds_read_b128 v[96:99], v220 offset:3008
  ds_read_b128 v[100:103], v220 offset:3520
  ds_read_b128 v[104:107], v220 offset:4032
  ds_read_b128 v[120:123], v220 offset:432
  ds_read2_b32 v[112:113], v216 offset0:128 offset1:129
  ds_read2_b32 v[114:115], v216 offset0:130 offset1:131
  s_waitcnt lgkmcnt(10)
  v_mfma_f32_16x16x32_bf16 v[44:47], v[108:111], v[76:79], 0
  ds_read_b128 v[124:127], v220 offset:944
  s_waitcnt lgkmcnt(10)
  v_mfma_f32_16x16x32_bf16 v[48:51], v[108:111], v[80:83], 0
  ds_read_b32 v25, v222
  s_waitcnt lgkmcnt(10)
  v_mfma_f32_16x16x32_bf16 v[52:55], v[108:111], v[84:87], 0
  ds_read2_b32 v[116:117], v216 offset0:0 offset1:1
  s_waitcnt lgkmcnt(10)
  v_mfma_f32_16x16x32_bf16 v[56:59], v[108:111], v[88:91], 0
  ds_read2_b32 v[118:119], v216 offset0:2 offset1:3
  s_waitcnt lgkmcnt(10)
  v_mfma_f32_16x16x32_bf16 v[60:63], v[108:111], v[92:95], 0
  ds_read2_b32 v[148:149], v219 offset0:32 offset1:33
  s_waitcnt lgkmcnt(10)
  v_mfma_f32_16x16x32_bf16 v[64:67], v[108:111], v[96:99], 0
  ds_read2_b32 v[150:151], v219 offset0:34 offset1:35
  s_waitcnt lgkmcnt(10)
  v_mfma_f32_16x16x32_bf16 v[68:71], v[108:111], v[100:103], 0
  ds_read2_b32 v[156:157], v219 offset0:16 offset1:17
  s_waitcnt lgkmcnt(10)
  v_mfma_f32_16x16x32_bf16 v[72:75], v[108:111], v[104:107], 0
  ds_read2_b32 v[158:159], v219 offset0:18 offset1:19
  s_waitcnt lgkmcnt(10)
  v_mfma_f32_16x16x32_bf16 v[184:187], v[120:123], v[128:131], 0
  ds_read2_b32 v[164:165], v219 offset0:0 offset1:1
  v_mfma_f32_16x16x32_bf16 v[172:175], v[120:123], v[132:135], 0
  ds_read2_b32 v[166:167], v219 offset0:2 offset1:3
  v_mfma_f32_16x16x32_bf16 v[188:191], v[76:79], v[128:131], 0
  ds_read2_b32 v[152:153], v219 offset0:96 offset1:97
  v_mfma_f32_16x16x32_bf16 v[176:179], v[76:79], v[132:135], 0
  ds_read2_b32 v[154:155], v219 offset0:98 offset1:99
  v_cvt_pk_bf16_f32 v184, v184, v172
  v_mfma_f32_16x16x32_bf16 v[192:195], v[120:123], v[136:139], 0
  ds_read2_b32 v[160:161], v219 offset0:80 offset1:81
  v_cvt_pk_bf16_f32 v185, v185, v173
  v_mfma_f32_16x16x32_bf16 v[180:183], v[76:79], v[140:143], 0
  ds_read2_b32 v[162:163], v219 offset0:82 offset1:83
  v_cvt_pk_bf16_f32 v186, v186, v174
  s_waitcnt lgkmcnt(14)
  v_mfma_f32_16x16x32_bf16 v[48:51], v[112:115], v[76:79], v[48:51]
  ds_read2_b32 v[168:169], v219 offset0:64 offset1:65
  v_cvt_pk_bf16_f32 v187, v187, v175
  v_mfma_f32_16x16x32_bf16 v[52:55], v[112:115], v[80:83], v[52:55]
  ds_read2_b32 v[170:171], v219 offset0:66 offset1:67
  v_cvt_pk_bf16_f32 v188, v188, v176
  v_mfma_f32_16x16x32_bf16 v[56:59], v[112:115], v[84:87], v[56:59]
  ds_write_b128 v221, v[44:47] offset:0
  v_cvt_pk_bf16_f32 v189, v189, v177
  v_mfma_f32_16x16x32_bf16 v[60:63], v[112:115], v[88:91], v[60:63]
  ds_read2_b32 v[108:109], v219 offset0:160 offset1:161
  v_cvt_pk_bf16_f32 v190, v190, v178
  v_mfma_f32_16x16x32_bf16 v[64:67], v[112:115], v[92:95], v[64:67]
  ds_read2_b32 v[110:111], v219 offset0:162 offset1:163
  v_cvt_pk_bf16_f32 v191, v191, v179
  v_mfma_f32_16x16x32_bf16 v[68:71], v[112:115], v[96:99], v[68:71]
  ds_read2_b32 v[104:105], v219 offset0:144 offset1:145
  v_cvt_pk_bf16_f32 v192, v192, v180
  v_mfma_f32_16x16x32_bf16 v[72:75], v[112:115], v[100:103], v[72:75]
  ds_read2_b32 v[106:107], v219 offset0:146 offset1:147
  v_cvt_pk_bf16_f32 v193, v193, v181
  s_waitcnt lgkmcnt(15)
  v_mfma_f32_16x16x32_bf16 v[40:43], v[124:127], v[128:131], 0
  ds_read2_b32 v[196:197], v219 offset0:128 offset1:129
  v_cvt_pk_bf16_f32 v194, v194, v182
  v_mfma_f32_16x16x32_bf16 v[172:175], v[124:127], v[132:135], 0
  ds_read2_b32 v[198:199], v219 offset0:130 offset1:131
  v_cvt_pk_bf16_f32 v195, v195, v183
  v_mfma_f32_16x16x32_bf16 v[112:115], v[80:83], v[128:131], 0
  ds_read2_b32 v[200:201], v219 offset0:176 offset1:177
  v_and_b32 v144, v25, v144
  v_mfma_f32_16x16x32_bf16 v[176:179], v[80:83], v[132:135], 0
  ds_read2_b32 v[202:203], v219 offset0:178 offset1:179
  v_and_b32 v145, v25, v145
  v_mfma_f32_16x16x32_bf16 v[100:103], v[124:127], v[136:139], 0
  ds_read_b128 v[120:123], v220 offset:1456
  v_and_b32 v146, v25, v146
  v_mfma_f32_16x16x32_bf16 v[180:183], v[80:83], v[140:143], 0
  ds_write_b128 v221, v[48:51] offset:1280
  v_and_b32 v147, v25, v147
  s_nop 1
  v_mfma_f32_16x16x32_bf16 v[60:63], v[144:147], v[76:79], v[60:63]
  ds_read_b128 v[124:127], v220 offset:1968
  v_cvt_pk_bf16_f32 v40, v40, v172
  v_mfma_f32_16x16x32_bf16 v[52:55], v[184:187], v[148:151], v[52:55]
  v_cvt_pk_bf16_f32 v41, v41, v173
  v_cvt_pk_bf16_f32 v42, v42, v174
  s_waitcnt lgkmcnt(15)
  v_mfma_f32_16x16x32_bf16 v[56:59], v[184:187], v[156:159], v[56:59]
  v_cvt_pk_bf16_f32 v43, v43, v175
  v_cvt_pk_bf16_f32 v112, v112, v176
  v_mfma_f32_16x16x32_bf16 v[60:63], v[184:187], v[164:167], v[60:63]
  v_cvt_pk_bf16_f32 v113, v113, v177
  v_cvt_pk_bf16_f32 v114, v114, v178
  v_mfma_f32_16x16x32_bf16 v[52:55], v[116:119], v[76:79], v[52:55]
  v_cvt_pk_bf16_f32 v115, v115, v179
  v_cvt_pk_bf16_f32 v100, v100, v180
  s_waitcnt lgkmcnt(9)
  v_mfma_f32_16x16x32_bf16 v[64:67], v[192:195], v[108:111], v[64:67]
  v_cvt_pk_bf16_f32 v101, v101, v181
  v_cvt_pk_bf16_f32 v102, v102, v182
  s_waitcnt lgkmcnt(7)
  v_mfma_f32_16x16x32_bf16 v[68:71], v[192:195], v[104:107], v[68:71]
  v_cvt_pk_bf16_f32 v103, v103, v183
  s_waitcnt lgkmcnt(5)
  v_mfma_f32_16x16x32_bf16 v[72:75], v[192:195], v[196:199], v[72:75]
  v_mfma_f32_16x16x32_bf16 v[56:59], v[188:191], v[160:163], v[56:59]
  v_mfma_f32_16x16x32_bf16 v[60:63], v[188:191], v[168:171], v[60:63]
  v_mfma_f32_16x16x32_bf16 v[52:55], v[188:191], v[152:155], v[52:55]
  s_waitcnt lgkmcnt(3)
  v_mfma_f32_16x16x32_bf16 v[60:63], v[192:195], v[200:203], v[60:63]
  ds_read2_b32 v[196:197], v217 offset0:16 offset1:17
  s_waitcnt lgkmcnt(3)
  v_mfma_f32_16x16x32_bf16 v[184:187], v[120:123], v[128:131], 0
  ds_read2_b32 v[198:199], v217 offset0:18 offset1:19
  v_mfma_f32_16x16x32_bf16 v[172:175], v[120:123], v[132:135], 0
  ds_read_b128 v[76:79], v220 offset:2048
  v_mfma_f32_16x16x32_bf16 v[188:191], v[84:87], v[128:131], 0
  ds_write_b128 v221, v[52:55] offset:2560
  v_mfma_f32_16x16x32_bf16 v[176:179], v[84:87], v[132:135], 0
  v_cvt_pk_bf16_f32 v184, v184, v172
  v_cvt_pk_bf16_f32 v185, v185, v173
  v_mfma_f32_16x16x32_bf16 v[192:195], v[120:123], v[136:139], 0
  ds_read_b128 v[120:123], v220 offset:2480
  v_cvt_pk_bf16_f32 v186, v186, v174
  v_mfma_f32_16x16x32_bf16 v[180:183], v[84:87], v[140:143], 0
  v_cvt_pk_bf16_f32 v187, v187, v175
  v_cvt_pk_bf16_f32 v188, v188, v176
  v_mfma_f32_16x16x32_bf16 v[64:67], v[144:147], v[80:83], v[64:67]
  v_cvt_pk_bf16_f32 v189, v189, v177
  v_cvt_pk_bf16_f32 v190, v190, v178
  v_mfma_f32_16x16x32_bf16 v[56:59], v[40:43], v[148:151], v[56:59]
  v_cvt_pk_bf16_f32 v191, v191, v179
  v_cvt_pk_bf16_f32 v192, v192, v180
  v_mfma_f32_16x16x32_bf16 v[60:63], v[40:43], v[156:159], v[60:63]
  v_cvt_pk_bf16_f32 v193, v193, v181
  v_cvt_pk_bf16_f32 v194, v194, v182
  v_mfma_f32_16x16x32_bf16 v[64:67], v[40:43], v[164:167], v[64:67]
  v_cvt_pk_bf16_f32 v195, v195, v183
  v_mfma_f32_16x16x32_bf16 v[56:59], v[116:119], v[80:83], v[56:59]
  v_mfma_f32_16x16x32_bf16 v[68:71], v[100:103], v[108:111], v[68:71]
  v_mfma_f32_16x16x32_bf16 v[72:75], v[100:103], v[104:107], v[72:75]
  v_mfma_f32_16x16x32_bf16 v[60:63], v[112:115], v[160:163], v[60:63]
  v_mfma_f32_16x16x32_bf16 v[64:67], v[112:115], v[168:171], v[64:67]
  v_mfma_f32_16x16x32_bf16 v[56:59], v[112:115], v[152:155], v[56:59]
  v_mfma_f32_16x16x32_bf16 v[64:67], v[100:103], v[200:203], v[64:67]
  ds_read2_b32 v[104:105], v216 offset0:16 offset1:17
  s_waitcnt lgkmcnt(6)
  v_mfma_f32_16x16x32_bf16 v[40:43], v[124:127], v[128:131], 0
  ds_read2_b32 v[106:107], v216 offset0:18 offset1:19
  v_mfma_f32_16x16x32_bf16 v[172:175], v[124:127], v[132:135], 0
  ds_read_b128 v[80:83], v220 offset:2560
  v_mfma_f32_16x16x32_bf16 v[112:115], v[88:91], v[128:131], 0
  ds_write_b128 v221, v[56:59] offset:3840
  v_mfma_f32_16x16x32_bf16 v[176:179], v[88:91], v[132:135], 0
  v_cvt_pk_bf16_f32 v40, v40, v172
  v_cvt_pk_bf16_f32 v41, v41, v173
  v_mfma_f32_16x16x32_bf16 v[100:103], v[124:127], v[136:139], 0
  ds_read_b128 v[124:127], v220 offset:2992
  v_cvt_pk_bf16_f32 v42, v42, v174
  v_mfma_f32_16x16x32_bf16 v[180:183], v[88:91], v[140:143], 0
  v_cvt_pk_bf16_f32 v43, v43, v175
  v_lshrrev_b32 v24, 5, v2
  v_mfma_f32_16x16x32_bf16 v[68:71], v[144:147], v[84:87], v[68:71]
  v_bfe_u32 v31, v2, 3, 1
  v_mul_u32_u24 v31, 87360, v31
  v_mfma_f32_16x16x32_bf16 v[60:63], v[184:187], v[148:151], v[60:63]
  v_sub_u32 v31, 162944, v31
  v_lshl_add_u32 v21, v24, 4, v31
  v_mfma_f32_16x16x32_bf16 v[64:67], v[184:187], v[156:159], v[64:67]
  s_mov_b32 s18, 0xf0f00f0f
  s_mov_b32 s19, 0xf0f00f0f
  v_mfma_f32_16x16x32_bf16 v[68:71], v[184:187], v[164:167], v[68:71]
  v_mov_b32 v31, 0x30000
  v_cndmask_b32 v21, v31, v21, s[18:19]
  s_and_b32 s3, s35, 1
  v_mfma_f32_16x16x32_bf16 v[60:63], v[116:119], v[84:87], v[60:63]
  s_lshl2_add_u32 s3, s3, 125920
  v_mov_b32 v27, s3
  v_mfma_f32_16x16x32_bf16 v[72:75], v[192:195], v[108:111], v[72:75]
  s_lshl2_add_u32 s3, s35, 162944
  v_mov_b32 v26, s3
  v_mfma_f32_16x16x32_bf16 v[64:67], v[188:191], v[160:163], v[64:67]
  v_cvt_pk_bf16_f32 v112, v112, v176
  v_cvt_pk_bf16_f32 v113, v113, v177
  v_mfma_f32_16x16x32_bf16 v[68:71], v[188:191], v[168:171], v[68:71]
  v_cvt_pk_bf16_f32 v114, v114, v178
  v_cvt_pk_bf16_f32 v115, v115, v179
  v_mfma_f32_16x16x32_bf16 v[60:63], v[188:191], v[152:155], v[60:63]
  v_cvt_pk_bf16_f32 v100, v100, v180
  v_cvt_pk_bf16_f32 v101, v101, v181
  v_mfma_f32_16x16x32_bf16 v[68:71], v[192:195], v[200:203], v[68:71]
  ds_read_b128 v[108:111], v220 offset:3072
  v_cvt_pk_bf16_f32 v102, v102, v182
  s_waitcnt lgkmcnt(6)
  v_mfma_f32_16x16x32_bf16 v[184:187], v[120:123], v[128:131], 0
  ds_read_b128 v[84:87], v220 offset:3584
  v_cvt_pk_bf16_f32 v103, v103, v183
  v_mfma_f32_16x16x32_bf16 v[172:175], v[120:123], v[132:135], 0
  v_mfma_f32_16x16x32_bf16 v[188:191], v[92:95], v[128:131], 0
  v_mfma_f32_16x16x32_bf16 v[176:179], v[92:95], v[132:135], 0
  v_cvt_pk_bf16_f32 v184, v184, v172
  v_cvt_pk_bf16_f32 v185, v185, v173
  v_mfma_f32_16x16x32_bf16 v[72:75], v[144:147], v[88:91], v[72:75]
  v_cvt_pk_bf16_f32 v186, v186, v174
  v_cvt_pk_bf16_f32 v187, v187, v175
  v_mfma_f32_16x16x32_bf16 v[64:67], v[40:43], v[148:151], v[64:67]
  v_cvt_pk_bf16_f32 v188, v188, v176
  v_cvt_pk_bf16_f32 v189, v189, v177
  v_mfma_f32_16x16x32_bf16 v[68:71], v[40:43], v[156:159], v[68:71]
  v_cvt_pk_bf16_f32 v190, v190, v178
  v_cvt_pk_bf16_f32 v191, v191, v179
  v_mfma_f32_16x16x32_bf16 v[72:75], v[40:43], v[164:167], v[72:75]
  v_mfma_f32_16x16x32_bf16 v[64:67], v[116:119], v[88:91], v[64:67]
  v_mfma_f32_16x16x32_bf16 v[68:71], v[112:115], v[160:163], v[68:71]
  v_mfma_f32_16x16x32_bf16 v[72:75], v[112:115], v[168:171], v[72:75]
  v_mfma_f32_16x16x32_bf16 v[64:67], v[112:115], v[152:155], v[64:67]
  v_mfma_f32_16x16x32_bf16 v[72:75], v[100:103], v[200:203], v[72:75]
  s_waitcnt lgkmcnt(2)
  v_mfma_f32_16x16x32_bf16 v[40:43], v[124:127], v[128:131], 0
  v_mfma_f32_16x16x32_bf16 v[172:175], v[124:127], v[132:135], 0
  v_mfma_f32_16x16x32_bf16 v[112:115], v[96:99], v[128:131], 0
  v_mfma_f32_16x16x32_bf16 v[176:179], v[96:99], v[132:135], 0
  v_cvt_pk_bf16_f32 v40, v40, v172
  v_cvt_pk_bf16_f32 v41, v41, v173
  v_mfma_f32_16x16x32_bf16 v[60:63], v[196:199], v[76:79], v[60:63]
  v_cvt_pk_bf16_f32 v42, v42, v174
  v_cvt_pk_bf16_f32 v43, v43, v175
  v_mfma_f32_16x16x32_bf16 v[64:67], v[104:107], v[76:79], v[64:67]
  v_cvt_pk_bf16_f32 v112, v112, v176
  v_cvt_pk_bf16_f32 v113, v113, v177
  v_mfma_f32_16x16x32_bf16 v[68:71], v[184:187], v[148:151], v[68:71]
  v_cvt_pk_bf16_f32 v114, v114, v178
  v_cvt_pk_bf16_f32 v115, v115, v179
  v_mfma_f32_16x16x32_bf16 v[72:75], v[116:119], v[96:99], v[72:75]
  ds_write_b128 v221, v[60:63] offset:5120
  v_mfma_f32_16x16x32_bf16 v[64:67], v[196:199], v[80:83], v[64:67]
  v_mfma_f32_16x16x32_bf16 v[72:75], v[184:187], v[156:159], v[72:75]
  v_mfma_f32_16x16x32_bf16 v[68:71], v[116:119], v[92:95], v[68:71]
  v_mfma_f32_16x16x32_bf16 v[72:75], v[188:191], v[160:163], v[72:75]
  ds_write_b128 v221, v[64:67] offset:6400
  v_mfma_f32_16x16x32_bf16 v[68:71], v[104:107], v[80:83], v[68:71]
  v_mfma_f32_16x16x32_bf16 v[72:75], v[40:43], v[148:151], v[72:75]
  s_waitcnt lgkmcnt(3)
  v_mfma_f32_16x16x32_bf16 v[68:71], v[196:199], v[108:111], v[68:71]
  v_mfma_f32_16x16x32_bf16 v[72:75], v[104:107], v[108:111], v[72:75]
  v_mfma_f32_16x16x32_bf16 v[68:71], v[188:191], v[152:155], v[68:71]
  v_mfma_f32_16x16x32_bf16 v[72:75], v[112:115], v[152:155], v[72:75]
  s_waitcnt lgkmcnt(2)
  v_mfma_f32_16x16x32_bf16 v[72:75], v[196:199], v[84:87], v[72:75]
  ds_write_b128 v221, v[68:71] offset:7680
  s_nop 6
  ds_write_b128 v221, v[72:75] offset:8960
  s_waitcnt vmcnt(0)
F_b4:
  s_waitcnt lgkmcnt(0)
  s_barrier
  ds_read_b32 v41, v27
  ds_read_b32 v43, v26
  ds_read_b128 v[80:83], v213 offset:0
  ds_read_b128 v[88:91], v213 offset:10240
  ds_read_b128 v[84:87], v213 offset:55104
  ds_read_b128 v[92:95], v213 offset:65344
  s_cmp_lg_u32 s38, 0
  s_waitcnt lgkmcnt(4)
  v_lshlrev_b32 v40, 16, v41
  v_and_b32 v41, 0xffff0000, v41
  v_lshlrev_b32 v42, 16, v43
  v_and_b32 v43, 0xffff0000, v43
  s_waitcnt lgkmcnt(2)
  v_pk_add_f32 v[80:81], v[80:81], v[88:89]
  v_pk_add_f32 v[82:83], v[82:83], v[90:91]
  v_fma_f32 v80, v40, v80, v32
  v_fma_f32 v81, v40, v81, v34
  v_fma_f32 v82, v40, v82, v36
  v_fma_f32 v83, v40, v83, v38
  v_pk_mul_f32 v[96:97], v[42:43], v[80:81] op_sel_hi:[0,1]
  v_pk_mul_f32 v[98:99], v[42:43], v[82:83] op_sel_hi:[0,1]
  v_cvt_pk_bf16_f32 v76, v96, v97
  v_cvt_pk_bf16_f32 v77, v98, v99
  v_min_u32 v77, 0xfffeffff, v77
  s_waitcnt lgkmcnt(0)
  v_pk_add_f32 v[84:85], v[84:85], v[92:93]
  v_pk_add_f32 v[86:87], v[86:87], v[94:95]
  v_fma_f32 v84, v41, v84, v33
  v_fma_f32 v85, v41, v85, v35
  v_fma_f32 v86, v41, v86, v37
  v_fma_f32 v87, v41, v87, v39
  v_pk_mul_f32 v[96:97], v[42:43], v[84:85] op_sel:[1,0]
  v_pk_mul_f32 v[98:99], v[42:43], v[86:87] op_sel:[1,0]
  v_cvt_pk_bf16_f32 v78, v96, v97
  v_cvt_pk_bf16_f32 v79, v98, v99
  global_store_dwordx4 v206, v[76:79], s[20:21] sc1
  s_setprio 0
  s_cbranch_scc1 G_xb
  ds_read_b64_tr_b16 v[208:209], v18 offset:12288
  ds_read_b64_tr_b16 v[210:211], v18 offset:12544
  ds_read_b64_tr_b16 v[116:117], v18 offset:16384
  ds_read_b64_tr_b16 v[118:119], v18 offset:16640
  s_add_u32 s64, s64, 114688
  s_addc_u32 s65, s65, 0
  s_add_u32 m0, s50, 138368
  s_add_u32 s64, s64, 57344
  s_addc_u32 s65, s65, 0
  global_load_lds_dwordx4 v223, s[64:65]
  s_and_b32 s45, s33, 1
  s_cselect_b32 s46, 0, 109696
  s_lshr_b32 s47, s33, 1
  s_lshl_b32 s26, s47, 10
  s_add_u32 s26, s26, s46
  s_mul_i32 s27, s47, -3072
  s_add_u32 m0, s50, 142464
  s_add_u32 s64, s64, 57344
  s_addc_u32 s65, s65, 0
  global_load_lds_dwordx4 v223, s[64:65]
  s_sub_u32 s27, s27, 114688
  s_lshl_b32 s44, s66, 2
  s_add_u32 s44, s44, s45
  s_mul_i32 s44, s44, 57344
  s_mul_i32 s28, s47, 3584
  s_add_u32 m0, s50, 146560
  s_add_u32 s64, s64, 57344
  s_addc_u32 s65, s65, 0
  global_load_lds_dwordx4 v223, s[64:65]
  s_add_u32 s29, s28, s44
  s_add_u32 s29, s29, 21086208
  v_and_b32 v15, 7, v2
  v_lshl_add_u32 v15, v15, 4, s29
  v_lshrrev_b32 v6, 4, v2
  s_add_u32 m0, s50, 154752
  s_add_u32 s64, s64, 57344
  s_addc_u32 s65, s65, 0
  global_load_lds_dwordx4 v223, s[64:65]
  v_lshl_add_u32 v15, v6, 7, v15
  v_bfe_u32 v6, v2, 3, 1
  v_mul_u32_u24 v6, 28672, v6
  v_add_u32 v15, v15, v6
  s_lshl_b32 s28, s28, 1
  s_add_u32 m0, s50, 158848
  s_add_u32 s64, s64, 57344
  s_addc_u32 s65, s65, 0
  global_load_lds_dwordx4 v223, s[64:65]
  s_mul_i32 s46, s45, 28672
  s_add_u32 s28, s28, s46
  s_add_u32 s28, s28, 28672
  v_add3_u32 v14, s26, v3, 0
  v_lshrrev_b32 v6, 5, v2
  s_add_u32 m0, s50, 30016
  s_add_u32 s64, s64, 57344
  s_addc_u32 s65, s65, 0
  global_load_lds_dwordx4 v223, s[64:65]
  v_lshlrev_b32 v5, 9, v6
  v_bfe_u32 v7, v2, 3, 1
  v_lshl_add_u32 v5, v7, 6, v5
  v_bfe_u32 v8, v2, 4, 1
  v_lshl_add_u32 v5, v8, 7, v5
  s_add_u32 m0, s50, 34112
  s_add_u32 s64, s64, 57344
  s_addc_u32 s65, s65, 0
  global_load_lds_dwordx4 v223, s[64:65]
  v_and_b32 v7, 3, v2
  v_lshl_add_u32 v5, v7, 4, v5
  v_and_b32 v9, 4, v2
  v_lshl_add_u32 v5, v9, 1, v5
  s_cmp_eq_u32 s38, 0
  s_cselect_b32 s46, 109696, 0
  s_cselect_b32 s44, 0, 109696
  s_add_u32 m0, s50, 38208
  s_add_u32 s64, s64, 57344
  s_addc_u32 s65, s65, 0
  global_load_lds_dwordx4 v223, s[64:65]
  s_mul_i32 s52, s38, 138368
  v_add_u32 v12, s46, v5
  v_add_u32 v13, s44, v5
  s_sub_u32 s53, 57344, s52
  s_sub_u32 s52, s52, 81024
  s_add_u32 m0, s50, 42304
  s_add_u32 s64, s64, 57344
  s_addc_u32 s65, s65, 0
  global_load_lds_dwordx4 v223, s[64:65]
  s_add_u32 m0, s50, 46400
  s_add_u32 s64, s64, 57344
  s_addc_u32 s65, s65, 0
  global_load_lds_dwordx4 v223, s[64:65]
  s_add_u32 m0, s50, 50496
  s_add_u32 s64, s64, 57344
  s_addc_u32 s65, s65, 0
  global_load_lds_dwordx4 v223, s[64:65]
  s_add_u32 m0, s50, 76928
  s_add_u32 s64, s64, 57344
  s_addc_u32 s65, s65, 0
  global_load_lds_dwordx4 v223, s[64:65]
  s_waitcnt lgkmcnt(2)
  s_add_u32 m0, s50, 89216
  s_add_u32 s64, s64, 57344
  s_addc_u32 s65, s65, 0
  global_load_lds_dwordx4 v223, s[64:65]
  s_waitcnt lgkmcnt(0)
  s_add_u32 m0, s50, 93312
  s_add_u32 s64, s64, 57344
  s_addc_u32 s65, s65, 0
  global_load_lds_dwordx4 v223, s[64:65]
  ds_read_b128 v[44:47], v21 offset:0
  ds_read_b128 v[48:51], v21 offset:32
  ds_read_b128 v[52:55], v21 offset:64
  ds_read_b128 v[56:59], v21 offset:96
  ds_read_b128 v[60:63], v21 offset:128
  ds_read_b128 v[64:67], v21 offset:160
  ds_read_b128 v[68:71], v21 offset:192
  ds_read_b128 v[72:75], v21 offset:224
  ds_read_b128 v[96:99], v21 offset:768
  ds_read_b128 v[100:103], v21 offset:800
  ds_read_b128 v[104:107], v21 offset:832
  ds_read_b128 v[108:111], v21 offset:864
  s_waitcnt lgkmcnt(10)
  v_mfma_f32_16x16x32_bf16 v[92:95], v[44:47], v[224:227], 0
  v_mfma_f32_16x16x32_bf16 v[92:95], v[48:51], v[228:231], v[92:95]
  ds_read_b128 v[44:47], v21 offset:256
  ds_read_b128 v[48:51], v21 offset:288
  s_waitcnt lgkmcnt(10)
  v_mfma_f32_16x16x32_bf16 v[92:95], v[52:55], v[232:235], v[92:95]
  v_mfma_f32_16x16x32_bf16 v[92:95], v[56:59], v[236:239], v[92:95]
  ds_read_b128 v[52:55], v21 offset:320
  ds_read_b128 v[56:59], v21 offset:352
  s_waitcnt lgkmcnt(10)
  v_mfma_f32_16x16x32_bf16 v[92:95], v[60:63], v[240:243], v[92:95]
  v_mfma_f32_16x16x32_bf16 v[92:95], v[64:67], v[244:247], v[92:95]
  ds_read_b128 v[60:63], v21 offset:384
  ds_read_b128 v[64:67], v21 offset:416
  s_waitcnt lgkmcnt(10)
  v_mfma_f32_16x16x32_bf16 v[92:95], v[68:71], v[248:251], v[92:95]
  v_mfma_f32_16x16x32_bf16 v[92:95], v[72:75], v[252:255], v[92:95]
  ds_read_b128 v[68:71], v21 offset:448
  ds_read_b128 v[72:75], v21 offset:480
  s_waitcnt lgkmcnt(6)
  v_mfma_f32_16x16x32_bf16 v[92:95], v[44:47], v[208:211], v[92:95]
  v_mfma_f32_16x16x32_bf16 v[92:95], v[48:51], v[116:119], v[92:95]
  ds_read_b128 v[44:47], v21 offset:512
  ds_read_b128 v[48:51], v21 offset:544
  s_waitcnt vmcnt(14)
  s_barrier
  v_add_u32 v4, s27, v15
  s_add_u32 m0, s26, 0
  s_nop 0
  global_load_lds_dwordx4 v4, s[20:21] offset:0 sc1
  s_add_u32 m0, s26, 2048
  s_nop 0
  global_load_lds_dwordx4 v4, s[20:21] offset:2048 sc1
  s_waitcnt vmcnt(15)
  ds_read_b64_tr_b16 v[120:121], v20 offset:0
  ds_read_b64_tr_b16 v[122:123], v20 offset:256
  s_waitcnt vmcnt(14)
  ds_read_b64_tr_b16 v[124:125], v20 offset:4096
  ds_read_b64_tr_b16 v[126:127], v20 offset:4352
  s_waitcnt vmcnt(13)
  ds_read_b64_tr_b16 v[128:129], v20 offset:8192
  ds_read_b64_tr_b16 v[130:131], v20 offset:8448
  s_add_u32 m0, s26, 8192
  v_add_u32 v4, 4096, v4
  global_load_lds_dwordx4 v4, s[20:21] offset:0 sc1
  s_add_u32 m0, s26, 10240
  s_nop 0
  global_load_lds_dwordx4 v4, s[20:21] offset:2048 sc1
  s_add_u32 m0, s26, 16384
  v_add_u32 v4, 4096, v4
  global_load_lds_dwordx4 v4, s[20:21] offset:0 sc1
  s_add_u32 m0, s26, 18432
  s_nop 0
  global_load_lds_dwordx4 v4, s[20:21] offset:2048 sc1
  s_add_u32 m0, s26, 24576
  v_add_u32 v4, 4096, v4
  global_load_lds_dwordx4 v4, s[20:21] offset:0 sc1
  s_waitcnt vmcnt(17)
  ds_read_b64_tr_b16 v[132:133], v20 offset:16384
  ds_read_b64_tr_b16 v[134:135], v20 offset:16640
  s_waitcnt vmcnt(16)
  ds_read_b64_tr_b16 v[136:137], v20 offset:20480
  ds_read_b64_tr_b16 v[138:139], v20 offset:20736
  s_waitcnt vmcnt(15)
  ds_read_b64_tr_b16 v[140:141], v1 offset:30016
  ds_read_b64_tr_b16 v[142:143], v1 offset:30272
  s_waitcnt vmcnt(14)
  ds_read_b64_tr_b16 v[144:145], v1 offset:34112
  ds_read_b64_tr_b16 v[146:147], v1 offset:34368
  s_waitcnt vmcnt(13)
  ds_read_b64_tr_b16 v[148:149], v1 offset:38208
  ds_read_b64_tr_b16 v[150:151], v1 offset:38464
  s_waitcnt vmcnt(12)
  ds_read_b64_tr_b16 v[152:153], v1 offset:42304
  ds_read_b64_tr_b16 v[154:155], v1 offset:42560
  s_waitcnt vmcnt(11)
  ds_read_b64_tr_b16 v[156:157], v1 offset:46400
  ds_read_b64_tr_b16 v[158:159], v1 offset:46656
  s_waitcnt vmcnt(10)
  ds_read_b64_tr_b16 v[160:161], v1 offset:50496
  ds_read_b64_tr_b16 v[162:163], v1 offset:50752
  s_waitcnt vmcnt(9)
  ds_read_b64_tr_b16 v[164:165], v18 offset:0
  ds_read_b64_tr_b16 v[166:167], v18 offset:256
  s_waitcnt vmcnt(8)
  ds_read_b64_tr_b16 v[168:169], v18 offset:12288
  ds_read_b64_tr_b16 v[170:171], v18 offset:12544
  s_waitcnt vmcnt(7)
  ds_read_b64_tr_b16 v[172:173], v18 offset:16384
  ds_read_b64_tr_b16 v[174:175], v18 offset:16640
  s_waitcnt lgkmcnt(15)
  v_mfma_f32_16x16x32_bf16 v[92:95], v[52:55], v[120:123], v[92:95]
  v_mfma_f32_16x16x32_bf16 v[92:95], v[56:59], v[124:127], v[92:95]
  ds_read_b128 v[52:55], v21 offset:576
  ds_read_b128 v[56:59], v21 offset:608
  s_waitcnt lgkmcnt(15)
  v_mfma_f32_16x16x32_bf16 v[92:95], v[60:63], v[128:131], v[92:95]
  v_mfma_f32_16x16x32_bf16 v[92:95], v[64:67], v[132:135], v[92:95]
  ds_read_b128 v[60:63], v21 offset:640
  ds_read_b128 v[64:67], v21 offset:672
  s_waitcnt lgkmcnt(15)
  v_mfma_f32_16x16x32_bf16 v[92:95], v[68:71], v[136:139], v[92:95]
  v_mfma_f32_16x16x32_bf16 v[92:95], v[72:75], v[140:143], v[92:95]
  ds_read_b128 v[68:71], v21 offset:704
  ds_read_b128 v[72:75], v21 offset:736
  s_waitcnt lgkmcnt(15)
  v_mfma_f32_16x16x32_bf16 v[92:95], v[44:47], v[144:147], v[92:95]
  v_mfma_f32_16x16x32_bf16 v[92:95], v[48:51], v[148:151], v[92:95]
  s_waitcnt lgkmcnt(4)
  v_mfma_f32_16x16x32_bf16 v[92:95], v[52:55], v[152:155], v[92:95]
  v_mfma_f32_16x16x32_bf16 v[92:95], v[56:59], v[156:159], v[92:95]
  s_waitcnt lgkmcnt(2)
  v_mfma_f32_16x16x32_bf16 v[92:95], v[60:63], v[160:163], v[92:95]
  v_mfma_f32_16x16x32_bf16 v[92:95], v[64:67], v[164:167], v[92:95]
  s_waitcnt lgkmcnt(0)
  v_mfma_f32_16x16x32_bf16 v[92:95], v[68:71], v[168:171], v[92:95]
  v_mfma_f32_16x16x32_bf16 v[92:95], v[72:75], v[172:175], v[92:95]
  v_add_u32 v20, s59, v1
G_xw:
  s_waitcnt vmcnt(5)
  ds_read_b64 v[84:85], v14 offset:0
  ds_read_b64 v[86:87], v14 offset:4096
  s_waitcnt lgkmcnt(0)
  v_max_u32 v85, v85, v87
  v_cmp_le_u32 vcc, 0xffff0000, v85
  s_cbranch_vccnz G_xs
G_go:
  s_barrier
  ds_read_b64_tr_b16 v[24:25], v12 offset:0
  ds_read_b64_tr_b16 v[26:27], v12 offset:256
  ds_read_b64_tr_b16 v[28:29], v13 offset:0
  ds_read_b64_tr_b16 v[30:31], v13 offset:256
  s_setprio 3
  s_waitcnt lgkmcnt(2)
  v_mfma_f32_32x32x16_bf16 v[52:67], v[224:227], v[24:27], 0
  ds_read_b64_tr_b16 v[32:33], v12 offset:1024
  ds_read_b64_tr_b16 v[34:35], v12 offset:1280
  s_lshl_b32 s51, s33, 11
  s_add_u32 s51, s51, 90112
  s_add_u32 s74, s68, s33
  s_and_b32 s74, s74, 7
  s_waitcnt lgkmcnt(2)
  v_mfma_f32_32x32x16_bf16 v[68:83], v[224:227], v[28:31], 0
  ds_read_b64_tr_b16 v[36:37], v13 offset:1024
  ds_read_b64_tr_b16 v[38:39], v13 offset:1280
  s_mul_i32 s48, s74, 14336
  s_mul_i32 s44, s68, 229376
  s_add_u32 m0, s28, 0
  s_nop 0
  global_load_lds_dwordx4 v15, s[20:21] offset:0 sc1
  s_waitcnt lgkmcnt(2)
  v_mfma_f32_32x32x16_bf16 v[52:67], v[228:231], v[32:35], v[52:67]
  ds_read_b64_tr_b16 v[24:25], v12 offset:2048
  ds_read_b64_tr_b16 v[26:27], v12 offset:2304
  s_add_u32 s44, s44, s48
  s_add_u32 s44, s44, 10489856
  s_add_u32 s4, s20, s44
  s_addc_u32 s5, s21, 0
  v_add_u32 v1, 114688, v3
  s_waitcnt lgkmcnt(2)
  v_mfma_f32_32x32x16_bf16 v[68:83], v[228:231], v[36:39], v[68:83]
  ds_read_b64_tr_b16 v[28:29], v13 offset:2048
  ds_read_b64_tr_b16 v[30:31], v13 offset:2304
  s_lshl_b32 s44, s38, 9
  v_lshl_add_u32 v16, v2, 3, s44
  s_cmp_eq_u32 s38, 0
  s_cselect_b32 s71, 0, 0xff800000
  s_cselect_b32 s72, 0, 0x80008000
  s_add_u32 m0, s28, 512
  s_nop 0
  global_load_lds_dwordx4 v15, s[20:21] offset:512 sc1
  s_setprio 2
  s_waitcnt lgkmcnt(2)
  v_mfma_f32_32x32x16_bf16 v[52:67], v[232:235], v[24:27], v[52:67]
  ds_read_b64_tr_b16 v[32:33], v12 offset:3072
  ds_read_b64_tr_b16 v[34:35], v12 offset:3328
  s_lshl_b32 s44, s66, 11
  s_add_u32 s46, s44, 1867776
  s_add_u32 s22, s20, s46
  s_addc_u32 s23, s21, 0
  s_lshl1_add_u32 s44, s44, 131072
  s_waitcnt lgkmcnt(2)
  v_mfma_f32_32x32x16_bf16 v[68:83], v[232:235], v[28:31], v[68:83]
  ds_read_b64_tr_b16 v[36:37], v13 offset:3072
  ds_read_b64_tr_b16 v[38:39], v13 offset:3328
  s_add_u32 s12, s20, s44
  s_addc_u32 s13, s21, 0
  s_mul_i32 s44, s66, 458752
  s_add_u32 s44, s44, 12582912
  s_add_u32 m0, s28, 1024
  s_nop 0
  global_load_lds_dwordx4 v15, s[20:21] offset:1024 sc1
  s_waitcnt lgkmcnt(2)
  v_mfma_f32_32x32x16_bf16 v[52:67], v[236:239], v[32:35], v[52:67]
  ds_read_b64_tr_b16 v[24:25], v12 offset:4096
  ds_read_b64_tr_b16 v[26:27], v12 offset:4352
  s_waitcnt vmcnt(3)
  ds_read_b64 v[84:85], v14 offset:8192
  s_waitcnt lgkmcnt(3)
  v_mfma_f32_32x32x16_bf16 v[68:83], v[236:239], v[36:39], v[68:83]
  ds_read_b64_tr_b16 v[28:29], v13 offset:4096
  ds_read_b64_tr_b16 v[30:31], v13 offset:4352
  ds_read_b64 v[86:87], v14 offset:12288
  s_add_u32 m0, s28, 1536
  s_nop 0
  global_load_lds_dwordx4 v15, s[20:21] offset:1536 sc1
  s_setprio 1
  s_waitcnt lgkmcnt(4)
  v_mfma_f32_32x32x16_bf16 v[52:67], v[240:243], v[24:27], v[52:67]
  ds_read_b64_tr_b16 v[32:33], v12 offset:5120
  ds_read_b64_tr_b16 v[34:35], v12 offset:5376
  ds_read_b64 v[88:89], v14 offset:16384
  ds_read_b64 v[90:91], v14 offset:20480
  s_waitcnt lgkmcnt(5)
  v_mfma_f32_32x32x16_bf16 v[68:83], v[240:243], v[28:31], v[68:83]
  ds_read_b64_tr_b16 v[36:37], v13 offset:5120
  ds_read_b64_tr_b16 v[38:39], v13 offset:5376
  ds_read_b64 v[40:41], v14 offset:24576
  s_add_u32 m0, s28, 2048
  s_nop 0
  global_load_lds_dwordx4 v15, s[20:21] offset:2048 sc1
  s_waitcnt lgkmcnt(5)
  v_mfma_f32_32x32x16_bf16 v[52:67], v[244:247], v[32:35], v[52:67]
  ds_read_b64_tr_b16 v[24:25], v12 offset:6144
  ds_read_b64_tr_b16 v[26:27], v12 offset:6400
  s_waitcnt lgkmcnt(2)
  v_max3_u32 v85, v85, v87, v89
  v_max3_u32 v85, v85, v91, v41
  s_waitcnt lgkmcnt(3)
  v_mfma_f32_32x32x16_bf16 v[68:83], v[244:247], v[36:39], v[68:83]
  ds_read_b64_tr_b16 v[28:29], v13 offset:6144
  ds_read_b64_tr_b16 v[30:31], v13 offset:6400
  v_cmp_le_u32 vcc, 0xffff0000, v85
  s_add_u32 m0, s28, 2560
  s_nop 0
  global_load_lds_dwordx4 v15, s[20:21] offset:2560 sc1
  s_setprio 0
  s_waitcnt lgkmcnt(2)
  v_mfma_f32_32x32x16_bf16 v[52:67], v[248:251], v[24:27], v[52:67]
  ds_read_b64_tr_b16 v[32:33], v12 offset:7168
  ds_read_b64_tr_b16 v[34:35], v12 offset:7424
  s_cbranch_vccnz G_br
G_bo:
  s_waitcnt lgkmcnt(2)
  v_mfma_f32_32x32x16_bf16 v[68:83], v[248:251], v[28:31], v[68:83]
  ds_read_b64_tr_b16 v[36:37], v13 offset:7168
  ds_read_b64_tr_b16 v[38:39], v13 offset:7424
  s_add_u32 m0, s28, 3072
  s_nop 0
  global_load_lds_dwordx4 v15, s[20:21] offset:3072 sc1
  s_barrier
  s_waitcnt lgkmcnt(2)
  v_mfma_f32_32x32x16_bf16 v[52:67], v[252:255], v[32:35], v[52:67]
  ds_read_b64_tr_b16 v[24:25], v12 offset:8192
  ds_read_b64_tr_b16 v[26:27], v12 offset:8448
  s_add_u32 m0, s61, 0
  s_add_u32 s64, s64, 57344
  s_addc_u32 s65, s65, 0
  global_load_lds_dwordx4 v223, s[64:65]
  s_waitcnt lgkmcnt(2)
  v_mfma_f32_32x32x16_bf16 v[68:83], v[252:255], v[36:39], v[68:83]
  ds_read_b64_tr_b16 v[28:29], v13 offset:8192
  ds_read_b64_tr_b16 v[30:31], v13 offset:8448
  s_setprio 3
  s_waitcnt lgkmcnt(2)
  v_mfma_f32_32x32x16_bf16 v[52:67], v[208:211], v[24:27], v[52:67]
  ds_read_b64_tr_b16 v[32:33], v12 offset:9216
  ds_read_b64_tr_b16 v[34:35], v12 offset:9472
  s_add_u32 m0, s61, 4096
  s_add_u32 s64, s64, 57344
  s_addc_u32 s65, s65, 0
  global_load_lds_dwordx4 v223, s[64:65]
  v_add3_u32 v14, s28, v3, 0
  s_waitcnt lgkmcnt(2)
  v_mfma_f32_32x32x16_bf16 v[68:83], v[208:211], v[28:31], v[68:83]
  ds_read_b64_tr_b16 v[36:37], v13 offset:9216
  ds_read_b64_tr_b16 v[38:39], v13 offset:9472
  v_mov_b64 v[46:47], 0
  v_mov_b64 v[50:51], 0
  s_waitcnt lgkmcnt(2)
  v_mfma_f32_32x32x16_bf16 v[52:67], v[116:119], v[32:35], v[52:67]
  ds_read_b64_tr_b16 v[24:25], v12 offset:10240
  ds_read_b64_tr_b16 v[26:27], v12 offset:10496
  s_lshl_b32 s46, s70, 11
  s_add_u32 s46, s44, s46
  s_mul_i32 s47, s38, 114688
  s_add_u32 s46, s46, s47
  s_add_u32 s6, s20, s46
  s_addc_u32 s7, s21, 0
  s_mul_i32 s46, s67, 114688
  s_add_u32 s44, s44, s46
  s_add_u32 s44, s44, s48
  s_waitcnt lgkmcnt(2)
  v_mfma_f32_32x32x16_bf16 v[68:83], v[116:119], v[36:39], v[68:83]
  ds_read_b64_tr_b16 v[28:29], v13 offset:10240
  ds_read_b64_tr_b16 v[30:31], v13 offset:10496
  s_add_u32 s44, s44, 4096
  s_add_u32 m0, s51, 0
  s_add_u32 s64, s64, 57344
  s_addc_u32 s65, s65, 0
  global_load_lds_dwordx4 v223, s[64:65]
  v_mov_b64 v[112:113], -1
  v_mov_b64 v[114:115], -1
  v_add_u32 v5, 229376, v3
  v_xor_b32 v11, 512, v16
  v_mov_b32 v4, v16
  s_setprio 2
  s_waitcnt lgkmcnt(2)
  v_mfma_f32_32x32x16_bf16 v[52:67], v[120:123], v[24:27], v[52:67]
  ds_read_b64_tr_b16 v[32:33], v12 offset:11264
  ds_read_b64_tr_b16 v[34:35], v12 offset:11520
  s_add_u32 s8, s20, s44
  s_addc_u32 s9, s21, 0
  s_add_u32 s10, s8, 8192
  s_addc_u32 s11, s9, 0
  v_min_u32 v17, 13, v2
  s_mul_i32 s44, s74, 14
  v_add_u32 v17, s44, v17
  s_waitcnt lgkmcnt(2)
  v_mfma_f32_32x32x16_bf16 v[68:83], v[120:123], v[28:31], v[68:83]
  ds_read_b64_tr_b16 v[36:37], v13 offset:11264
  ds_read_b64_tr_b16 v[38:39], v13 offset:11520
  v_lshrrev_b32 v17, 3, v17
  v_lshlrev_b32 v17, 8, v17
  s_lshl_b32 s44, s69, 8
  v_mov_b32 v18, s44
  s_add_u32 m0, s51, 1024
  s_add_u32 s64, s64, 57344
  s_addc_u32 s65, s65, 0
  global_load_lds_dwordx4 v223, s[64:65]
  s_waitcnt lgkmcnt(2)
  v_mfma_f32_32x32x16_bf16 v[52:67], v[124:127], v[32:35], v[52:67]
  ds_read_b64_tr_b16 v[24:25], v12 offset:12288
  ds_read_b64_tr_b16 v[26:27], v12 offset:12544
  v_mov_b32 v19, s40
  s_bfe_u32 s54, s33, 0x10001
  v_lshrrev_b32 v9, 4, v2
  v_and_b32 v0, 15, v2
  s_lshl_b32 s46, s67, 9
  s_waitcnt lgkmcnt(2)
  v_mfma_f32_32x32x16_bf16 v[68:83], v[124:127], v[36:39], v[68:83]
  ds_read_b64_tr_b16 v[28:29], v13 offset:12288
  ds_read_b64_tr_b16 v[30:31], v13 offset:12544
  s_lshl_b32 s47, s45, 7
  s_add_u32 s46, s46, s47
  s_add_u32 s46, s46, 256
  v_lshl_add_u32 v7, v0, 3, s46
  global_store_dwordx4 v5, v[112:115], s[6:7] offset:0 sc1
  s_setprio 1
  s_waitcnt lgkmcnt(2)
  v_mfma_f32_32x32x16_bf16 v[52:67], v[128:131], v[24:27], v[52:67]
  ds_read_b64_tr_b16 v[32:33], v12 offset:13312
  ds_read_b64_tr_b16 v[34:35], v12 offset:13568
  s_cmp_eq_u32 s67, 0
  s_cselect_b32 s46, 109696, 0
  s_mul_i32 s55, s67, 138368
  s_sub_u32 s55, s55, 81024
  s_add_u32 s46, s46, s47
  s_lshl_b32 s47, s68, 12
  s_add_u32 s46, s46, s47
  s_waitcnt lgkmcnt(2)
  v_mfma_f32_32x32x16_bf16 v[68:83], v[128:131], v[28:31], v[68:83]
  ds_read_b64_tr_b16 v[36:37], v13 offset:13312
  ds_read_b64_tr_b16 v[38:39], v13 offset:13568
  s_lshl_b32 s47, s54, 11
  s_add_u32 s46, s46, s47
  v_lshl_add_u32 v8, v9, 9, s46
  v_and_b32 v10, 8, v2
  global_store_dwordx4 v5, v[112:115], s[6:7] offset:1024 sc1
  s_waitcnt lgkmcnt(2)
  v_mfma_f32_32x32x16_bf16 v[52:67], v[132:135], v[32:35], v[52:67]
  ds_read_b64_tr_b16 v[24:25], v12 offset:14336
  ds_read_b64_tr_b16 v[26:27], v12 offset:14592
  v_lshl_add_u32 v8, v10, 3, v8
  v_and_b32 v10, 3, v2
  v_lshl_add_u32 v8, v10, 4, v8
  v_and_b32 v10, 4, v2
  v_lshl_add_u32 v8, v10, 1, v8
  s_waitcnt lgkmcnt(2)
  v_mfma_f32_32x32x16_bf16 v[68:83], v[132:135], v[36:39], v[68:83]
  ds_read_b64_tr_b16 v[28:29], v13 offset:14336
  ds_read_b64_tr_b16 v[30:31], v13 offset:14592
  s_lshl2_add_u32 s44, s66, s67
  s_lshl1_add_u32 s44, s44, s45
  v_mul_u32_u24 v6, 896, v0
  v_lshl_add_u32 v6, v9, 4, v6
  s_setprio 0
  s_waitcnt lgkmcnt(2)
  v_mfma_f32_32x32x16_bf16 v[52:67], v[136:139], v[24:27], v[52:67]
  ds_read_b64_tr_b16 v[32:33], v12 offset:15360
  ds_read_b64_tr_b16 v[34:35], v12 offset:15616
  s_mul_i32 s44, s44, 14336
  s_lshl_b32 s46, s68, 7
  s_lshl_b32 s47, s54, 6
  s_add_u32 s46, s46, s47
  s_add_u32 s44, s44, s46
  s_waitcnt lgkmcnt(2)
  v_mfma_f32_32x32x16_bf16 v[68:83], v[136:139], v[28:31], v[68:83]
  ds_read_b64_tr_b16 v[36:37], v13 offset:15360
  ds_read_b64_tr_b16 v[38:39], v13 offset:15616
  s_add_u32 s62, s62, s44
  s_addc_u32 s63, s63, 0
  s_add_u32 s60, s46, 162944
  s_lshl_b32 s46, s46, 1
  s_add_u32 s46, s46, 1856768
  s_waitcnt lgkmcnt(2)
  v_mfma_f32_32x32x16_bf16 v[52:67], v[140:143], v[32:35], v[52:67]
  ds_read_b64_tr_b16 v[24:25], v12 offset:16384
  ds_read_b64_tr_b16 v[26:27], v12 offset:16640
  s_add_u32 s16, s20, s46
  s_addc_u32 s17, s21, 0
  s_lshl_b32 s44, s54, 12
  s_lshl_b32 s46, s45, 8
  s_add_u32 s44, s44, s46
  v_lshlrev_b32 v0, 4, v0
  s_waitcnt lgkmcnt(2)
  v_mfma_f32_32x32x16_bf16 v[68:83], v[140:143], v[36:39], v[68:83]
  ds_read_b64_tr_b16 v[28:29], v13 offset:16384
  ds_read_b64_tr_b16 v[30:31], v13 offset:16640
  v_lshl_add_u32 v0, v9, 9, v0
  v_add_u32 v0, s44, v0
  s_lshl_b32 s54, s33, 4
  s_add_u32 s54, s54, 162816
  s_lshl_b32 s49, s33, 13
  s_setprio 3
  s_waitcnt lgkmcnt(2)
  v_mfma_f32_32x32x16_bf16 v[52:67], v[144:147], v[24:27], v[52:67]
  ds_read_b64_tr_b16 v[32:33], v12 offset:17408
  ds_read_b64_tr_b16 v[34:35], v12 offset:17664
  s_sub_u32 s3, s51, s61
  v_add_u32 v21, s3, v20
  s_waitcnt vmcnt(5)
  ds_read_b64_tr_b16 v[176:177], v20 offset:0
  s_waitcnt lgkmcnt(3)
  v_mfma_f32_32x32x16_bf16 v[68:83], v[144:147], v[28:31], v[68:83]
  ds_read_b64_tr_b16 v[36:37], v13 offset:17408
  ds_read_b64_tr_b16 v[38:39], v13 offset:17664
  ds_read_b64_tr_b16 v[178:179], v20 offset:256
  v_add_u32 v16, s51, v3
  s_waitcnt lgkmcnt(4)
  v_mfma_f32_32x32x16_bf16 v[52:67], v[148:151], v[32:35], v[52:67]
  ds_read_b64_tr_b16 v[24:25], v12 offset:18432
  ds_read_b64_tr_b16 v[26:27], v12 offset:18688
  s_waitcnt vmcnt(4)
  ds_read_b64_tr_b16 v[180:181], v20 offset:4096
  s_waitcnt lgkmcnt(4)
  v_mfma_f32_32x32x16_bf16 v[68:83], v[148:151], v[36:39], v[68:83]
  ds_read_b64_tr_b16 v[28:29], v13 offset:18432
  ds_read_b64_tr_b16 v[30:31], v13 offset:18688
  ds_read_b64_tr_b16 v[182:183], v20 offset:4352
  s_setprio 2
  s_waitcnt lgkmcnt(4)
  v_mfma_f32_32x32x16_bf16 v[52:67], v[152:155], v[24:27], v[52:67]
  ds_read_b64_tr_b16 v[32:33], v12 offset:19456
  ds_read_b64_tr_b16 v[34:35], v12 offset:19712
  s_waitcnt lgkmcnt(8)
  v_mfma_f32_16x16x32_bf16 v[92:95], v[96:99], v[176:179], v[92:95]
  s_waitcnt vmcnt(3)
  ds_read_b64_tr_b16 v[184:185], v21 offset:0
  ds_read_b64_tr_b16 v[186:187], v21 offset:256
  v_and_b32 v84, 0x70, v3
  s_waitcnt lgkmcnt(5)
  v_mfma_f32_32x32x16_bf16 v[68:83], v[152:155], v[28:31], v[68:83]
  ds_read_b64_tr_b16 v[36:37], v13 offset:19456
  ds_read_b64_tr_b16 v[38:39], v13 offset:19712
  v_add_u32 v84, 162816, v84
  v_mov_b64 v[86:87], 0
  ds_write_b64 v84, v[86:87]
  global_load_dwordx2 v[44:45], v4, s[22:23] offset:0 sc1
  global_load_dwordx2 v[48:49], v11, s[22:23] offset:0 sc1
  s_waitcnt lgkmcnt(5)
  v_mfma_f32_32x32x16_bf16 v[52:67], v[156:159], v[32:35], v[52:67]
  ds_read_b64_tr_b16 v[24:25], v12 offset:20480
  ds_read_b64_tr_b16 v[26:27], v12 offset:20736
  s_waitcnt lgkmcnt(9)
  v_mfma_f32_16x16x32_bf16 v[92:95], v[100:103], v[180:183], v[92:95]
  s_waitcnt vmcnt(4)
  s_waitcnt lgkmcnt(3)
  v_mfma_f32_32x32x16_bf16 v[68:83], v[156:159], v[36:39], v[68:83]
  ds_read_b64_tr_b16 v[28:29], v13 offset:20480
  ds_read_b64_tr_b16 v[30:31], v13 offset:20736
  ds_read_b64_tr_b16 v[188:189], v21 offset:1024
  ds_read_b64_tr_b16 v[190:191], v21 offset:1280
  s_setprio 1
  s_waitcnt lgkmcnt(4)
  v_mfma_f32_32x32x16_bf16 v[52:67], v[160:163], v[24:27], v[52:67]
  ds_read_b64_tr_b16 v[32:33], v13 offset:21504
  ds_read_b64_tr_b16 v[34:35], v13 offset:21760
  s_waitcnt lgkmcnt(11)
  v_mfma_f32_16x16x32_bf16 v[92:95], v[104:107], v[184:187], v[92:95]
  s_waitcnt vmcnt(8)
  s_waitcnt lgkmcnt(4)
  v_mfma_f32_32x32x16_bf16 v[68:83], v[160:163], v[28:31], v[68:83]
  ds_read_b64_tr_b16 v[36:37], v12 offset:21504
  ds_read_b64_tr_b16 v[38:39], v12 offset:21760
  ds_read_b64 v[84:85], v14 offset:0
  s_waitcnt lgkmcnt(3)
  v_mfma_f32_32x32x16_bf16 v[68:83], v[164:167], v[32:35], v[68:83]
  ds_read_b64_tr_b16 v[24:25], v13 offset:22528
  ds_read_b64_tr_b16 v[26:27], v13 offset:22784
  s_waitcnt lgkmcnt(7)
  v_mfma_f32_16x16x32_bf16 v[92:95], v[108:111], v[188:191], v[92:95]
  ds_read_b64 v[86:87], v14 offset:1024
  s_waitcnt lgkmcnt(4)
  v_mfma_f32_32x32x16_bf16 v[52:67], v[164:167], v[36:39], v[52:67]
  ds_read_b64_tr_b16 v[28:29], v13 offset:23552
  ds_read_b64_tr_b16 v[30:31], v13 offset:23808
  ds_read_b64 v[88:89], v14 offset:2048
  ds_read_b64 v[90:91], v14 offset:3072
  s_setprio 0
  s_waitcnt lgkmcnt(5)
  v_mfma_f32_32x32x16_bf16 v[68:83], v[168:171], v[24:27], v[68:83]
  ds_read_b64_tr_b16 v[32:33], v12 offset:22528
  ds_read_b64_tr_b16 v[34:35], v12 offset:22784
  v_cvt_pk_bf16_f32 v193, v92, v92
  v_and_b32 v193, 0xffff0000, v193
  v_sub_f32 v192, v92, v193
  v_cvt_pk_bf16_f32 v192, v193, v192
  v_mov_b32 v193, 0
  s_waitcnt lgkmcnt(4)
  v_mfma_f32_32x32x16_bf16 v[68:83], v[172:175], v[28:31], v[68:83]
  ds_read_b64_tr_b16 v[36:37], v13 offset:24576
  ds_read_b64_tr_b16 v[38:39], v13 offset:24832
  v_mov_b64 v[194:195], 0
  global_load_dwordx4 v[200:203], v3, s[4:5] offset:-4096 sc1
  ds_read_b64 v[40:41], v14 offset:4096
  ds_read_b64 v[42:43], v14 offset:5120
  ds_read_b64 v[22:23], v14 offset:6144
  s_waitcnt lgkmcnt(5)
  v_mfma_f32_32x32x16_bf16 v[52:67], v[168:171], v[32:35], v[52:67]
  ds_read_b64_tr_b16 v[24:25], v13 offset:25600
  ds_read_b64_tr_b16 v[26:27], v13 offset:25856
  global_load_dwordx4 v[204:207], v1, s[4:5] offset:-4096 sc1
  s_waitcnt lgkmcnt(2)
  v_max3_u32 v85, v85, v87, v89
  s_waitcnt lgkmcnt(5)
  v_mfma_f32_32x32x16_bf16 v[68:83], v[176:179], v[36:39], v[68:83]
  ds_read_b64_tr_b16 v[28:29], v12 offset:23552
  ds_read_b64_tr_b16 v[30:31], v12 offset:23808
  v_max3_u32 v85, v85, v91, v41
  v_max3_u32 v85, v85, v43, v23
  v_cmp_le_u32 vcc, 0xffff0000, v85
  s_setprio 3
  s_waitcnt lgkmcnt(2)
  v_mfma_f32_32x32x16_bf16 v[68:83], v[180:183], v[24:27], v[68:83]
  ds_read_b64_tr_b16 v[32:33], v13 offset:26624
  ds_read_b64_tr_b16 v[34:35], v13 offset:26880
  s_cbranch_vccnz G_cr
G_co:
  global_load_dwordx4 v[196:199], v3, s[4:5] offset:-3072 sc1
  s_waitcnt vmcnt(3)
  v_xor_b32 v20, s40, v45
  s_waitcnt lgkmcnt(2)
  v_mfma_f32_32x32x16_bf16 v[52:67], v[172:175], v[28:31], v[52:67]
  ds_read_b64_tr_b16 v[36:37], v13 offset:27648
  ds_read_b64_tr_b16 v[38:39], v13 offset:27904
  v_xor_b32 v21, s40, v49
  v_or_b32 v20, v20, v21
  v_cmp_ne_u32 vcc, 0, v20
  s_waitcnt lgkmcnt(2)
  v_mfma_f32_32x32x16_bf16 v[68:83], v[184:187], v[32:35], v[68:83]
  ds_read_b64_tr_b16 v[24:25], v12 offset:24576
  ds_read_b64_tr_b16 v[26:27], v12 offset:24832
  s_cbranch_vccnz G_sr0
G_so0:
  global_load_dwordx4 v[212:215], v1, s[4:5] offset:-3072 sc1
  v_xor_b32 v14, 57344, v16
  s_waitcnt lgkmcnt(2)
  v_mfma_f32_32x32x16_bf16 v[68:83], v[188:191], v[36:39], v[68:83]
  ds_read_b64_tr_b16 v[28:29], v12 offset:25600
  ds_read_b64_tr_b16 v[30:31], v12 offset:25856
  v_mov_b32 v45, 0
  v_mov_b32 v49, 0
  s_nop 1
  v_mfma_f32_32x32x16_bf16 v[68:83], v[192:195], v[48:51], v[68:83]
  v_mfma_f32_32x32x16_bf16 v[52:67], v[192:195], v[44:47], v[52:67]
  s_setprio 2
  s_waitcnt lgkmcnt(2)
  v_mfma_f32_32x32x16_bf16 v[52:67], v[176:179], v[24:27], v[52:67]
  ds_read_b64_tr_b16 v[32:33], v12 offset:26624
  ds_read_b64_tr_b16 v[34:35], v12 offset:26880
  global_load_dwordx4 v[216:219], v3, s[4:5] offset:-2048 sc1
  v_cvt_pk_bf16_f32 v68, v68, v69
  v_cvt_pk_bf16_f32 v69, v70, v71
  v_cvt_pk_bf16_f32 v70, v72, v73
  v_cvt_pk_bf16_f32 v71, v74, v75
  v_pk_max_i16 v68, s72, v68
  v_pk_max_i16 v69, s72, v69
  v_pk_max_i16 v70, s72, v70
  v_pk_max_i16 v71, s72, v71
  ds_write_b128 v16, v[68:71] offset:0
  s_waitcnt lgkmcnt(3)
  v_mfma_f32_32x32x16_bf16 v[52:67], v[180:183], v[28:31], v[52:67]
  ds_read_b64_tr_b16 v[36:37], v12 offset:27648
  ds_read_b64_tr_b16 v[38:39], v12 offset:27904
  v_add_u32 v12, s52, v12
  v_add_u32 v13, s53, v13
  v_cvt_pk_bf16_f32 v72, v76, v77
  v_cvt_pk_bf16_f32 v73, v78, v79
  v_cvt_pk_bf16_f32 v74, v80, v81
  v_cvt_pk_bf16_f32 v75, v82, v83
  v_pk_max_i16 v72, s72, v72
  v_pk_max_i16 v73, s72, v73
  v_pk_max_i16 v74, s72, v74
  v_pk_max_i16 v75, s72, v75
  ds_write_b128 v16, v[72:75] offset:1024
  s_waitcnt lgkmcnt(0)
  s_barrier
  s_waitcnt lgkmcnt(4)
  v_mfma_f32_32x32x16_bf16 v[52:67], v[184:187], v[32:35], v[52:67]
  ds_read_b64_tr_b16 v[24:25], v12 offset:0
  ds_read_b64_tr_b16 v[26:27], v12 offset:256
  ds_read_b128 v[76:79], v14 offset:0
  ds_read_b128 v[80:83], v14 offset:1024
  s_waitcnt lgkmcnt(5)
  v_mfma_f32_32x32x16_bf16 v[52:67], v[188:191], v[36:39], v[52:67]
  ds_read_b64_tr_b16 v[28:29], v13 offset:0
  ds_read_b64_tr_b16 v[30:31], v13 offset:256
  global_load_dwordx4 v[220:223], v1, s[4:5] offset:-2048 sc1
  s_setprio 1
  s_waitcnt lgkmcnt(4)
  v_mfma_f32_32x32x16_bf16 v[84:99], v[224:227], v[24:27], 0
  ds_read_b64_tr_b16 v[32:33], v12 offset:1024
  ds_read_b64_tr_b16 v[34:35], v12 offset:1280
  global_load_dwordx2 v[44:45], v4, s[22:23] offset:1024 sc1
  global_load_dwordx2 v[48:49], v11, s[22:23] offset:1024 sc1
  s_waitcnt lgkmcnt(4)
  v_lshlrev_b32 v68, 16, v76
  v_and_b32 v69, 0xffff0000, v76
  v_lshlrev_b32 v70, 16, v77
  s_waitcnt lgkmcnt(2)
  v_mfma_f32_32x32x16_bf16 v[100:115], v[224:227], v[28:31], 0
  ds_read_b64_tr_b16 v[36:37], v13 offset:1024
  ds_read_b64_tr_b16 v[38:39], v13 offset:1280
  v_and_b32 v71, 0xffff0000, v77
  v_lshlrev_b32 v72, 16, v78
  v_and_b32 v73, 0xffff0000, v78
  v_lshlrev_b32 v74, 16, v79
  v_and_b32 v75, 0xffff0000, v79
  v_max_f32 v52, s71, v52
  s_waitcnt lgkmcnt(2)
  v_mfma_f32_32x32x16_bf16 v[84:99], v[228:231], v[32:35], v[84:99]
  ds_read_b64_tr_b16 v[24:25], v12 offset:2048
  ds_read_b64_tr_b16 v[26:27], v12 offset:2304
  v_max_f32 v53, s71, v53
  v_max_f32 v54, s71, v54
  v_max_f32 v55, s71, v55
  v_max_f32 v56, s71, v56
  v_max_f32 v57, s71, v57
  s_waitcnt lgkmcnt(2)
  v_mfma_f32_32x32x16_bf16 v[100:115], v[228:231], v[36:39], v[100:115]
  ds_read_b64_tr_b16 v[28:29], v13 offset:2048
  ds_read_b64_tr_b16 v[30:31], v13 offset:2304
  global_load_dwordx4 v[224:227], v3, s[4:5] offset:-1024 sc1
  v_max_f32 v58, s71, v58
  v_max_f32 v59, s71, v59
  v_mul_f32 v52, v52, v68
  v_mul_f32 v53, v53, v69
  v_mul_f32 v54, v54, v70
  s_setprio 0
  s_waitcnt lgkmcnt(2)
  v_mfma_f32_32x32x16_bf16 v[84:99], v[232:235], v[24:27], v[84:99]
  ds_read_b64_tr_b16 v[32:33], v12 offset:3072
  ds_read_b64_tr_b16 v[34:35], v12 offset:3328
  v_mul_f32 v55, v55, v71
  v_mul_f32 v56, v56, v72
  v_mul_f32 v57, v57, v73
  v_mul_f32 v58, v58, v74
  v_mul_f32 v59, v59, v75
  s_waitcnt lgkmcnt(2)
  v_mfma_f32_32x32x16_bf16 v[100:115], v[232:235], v[28:31], v[100:115]
  ds_read_b64_tr_b16 v[36:37], v13 offset:3072
  ds_read_b64_tr_b16 v[38:39], v13 offset:3328
  global_load_dwordx4 v[228:231], v1, s[4:5] offset:-1024 sc1
  v_cvt_pk_bf16_f32 v52, v52, v53
  v_cvt_pk_bf16_f32 v53, v54, v55
  v_cvt_pk_bf16_f32 v54, v56, v57
  v_cvt_pk_bf16_f32 v55, v58, v59
  global_store_dwordx4 v3, v[52:55], s[6:7] offset:0 sc1
  s_waitcnt lgkmcnt(2)
  v_mfma_f32_32x32x16_bf16 v[84:99], v[236:239], v[32:35], v[84:99]
  ds_read_b64_tr_b16 v[24:25], v12 offset:4096
  ds_read_b64_tr_b16 v[26:27], v12 offset:4352
  v_lshlrev_b32 v68, 16, v80
  v_and_b32 v69, 0xffff0000, v80
  v_lshlrev_b32 v70, 16, v81
  v_and_b32 v71, 0xffff0000, v81
  v_lshlrev_b32 v72, 16, v82
  s_waitcnt lgkmcnt(2)
  v_mfma_f32_32x32x16_bf16 v[100:115], v[236:239], v[36:39], v[100:115]
  ds_read_b64_tr_b16 v[28:29], v13 offset:4096
  ds_read_b64_tr_b16 v[30:31], v13 offset:4352
  global_load_dwordx4 v[232:235], v3, s[4:5] offset:0 sc1
  v_and_b32 v73, 0xffff0000, v82
  v_lshlrev_b32 v74, 16, v83
  v_and_b32 v75, 0xffff0000, v83
  v_max_f32 v60, s71, v60
  v_max_f32 v61, s71, v61
  s_setprio 3
  s_waitcnt lgkmcnt(2)
  v_mfma_f32_32x32x16_bf16 v[84:99], v[240:243], v[24:27], v[84:99]
  ds_read_b64_tr_b16 v[32:33], v12 offset:5120
  ds_read_b64_tr_b16 v[34:35], v12 offset:5376
  v_max_f32 v62, s71, v62
  v_max_f32 v63, s71, v63
  v_max_f32 v64, s71, v64
  v_max_f32 v65, s71, v65
  v_max_f32 v66, s71, v66
  s_waitcnt lgkmcnt(2)
  v_mfma_f32_32x32x16_bf16 v[100:115], v[240:243], v[28:31], v[100:115]
  ds_read_b64_tr_b16 v[36:37], v13 offset:5120
  ds_read_b64_tr_b16 v[38:39], v13 offset:5376
  global_load_dwordx4 v[236:239], v1, s[4:5] offset:0 sc1
  v_max_f32 v67, s71, v67
  v_mul_f32 v60, v60, v68
  v_mul_f32 v61, v61, v69
  v_mul_f32 v62, v62, v70
  v_mul_f32 v63, v63, v71
  s_waitcnt lgkmcnt(2)
  v_mfma_f32_32x32x16_bf16 v[84:99], v[244:247], v[32:35], v[84:99]
  ds_read_b64_tr_b16 v[24:25], v12 offset:6144
  ds_read_b64_tr_b16 v[26:27], v12 offset:6400
  v_mul_f32 v64, v64, v72
  v_mul_f32 v65, v65, v73
  v_mul_f32 v66, v66, v74
  v_mul_f32 v67, v67, v75
  v_cvt_pk_bf16_f32 v60, v60, v61
  s_waitcnt lgkmcnt(2)
  v_mfma_f32_32x32x16_bf16 v[100:115], v[244:247], v[36:39], v[100:115]
  ds_read_b64_tr_b16 v[28:29], v13 offset:6144
  ds_read_b64_tr_b16 v[30:31], v13 offset:6400
  v_cvt_pk_bf16_f32 v61, v62, v63
  v_cvt_pk_bf16_f32 v62, v64, v65
  v_cvt_pk_bf16_f32 v63, v66, v67
  global_store_dwordx4 v3, v[60:63], s[6:7] offset:1024 sc1
  s_add_u32 s6, s6, 229376
  s_addc_u32 s7, s7, 0
  s_setprio 2
  s_waitcnt lgkmcnt(2)
  v_mfma_f32_32x32x16_bf16 v[84:99], v[248:251], v[24:27], v[84:99]
  ds_read_b64_tr_b16 v[32:33], v12 offset:7168
  ds_read_b64_tr_b16 v[34:35], v12 offset:7424
  s_waitcnt lgkmcnt(2)
  v_mfma_f32_32x32x16_bf16 v[100:115], v[248:251], v[28:31], v[100:115]
  ds_read_b64_tr_b16 v[36:37], v13 offset:7168
  ds_read_b64_tr_b16 v[38:39], v13 offset:7424
  global_load_dwordx4 v[240:243], v3, s[4:5] offset:1024 sc1
  s_waitcnt lgkmcnt(2)
  v_mfma_f32_32x32x16_bf16 v[84:99], v[252:255], v[32:35], v[84:99]
  ds_read_b64_tr_b16 v[24:25], v12 offset:8192
  ds_read_b64_tr_b16 v[26:27], v12 offset:8448
  s_waitcnt lgkmcnt(2)
  v_mfma_f32_32x32x16_bf16 v[100:115], v[252:255], v[36:39], v[100:115]
  ds_read_b64_tr_b16 v[28:29], v13 offset:8192
  ds_read_b64_tr_b16 v[30:31], v13 offset:8448
  global_load_dwordx4 v[244:247], v1, s[4:5] offset:1024 sc1
  s_setprio 1
  s_waitcnt lgkmcnt(2)
  v_mfma_f32_32x32x16_bf16 v[84:99], v[208:211], v[24:27], v[84:99]
  ds_read_b64_tr_b16 v[32:33], v12 offset:9216
  ds_read_b64_tr_b16 v[34:35], v12 offset:9472
  s_waitcnt lgkmcnt(2)
  v_mfma_f32_32x32x16_bf16 v[100:115], v[208:211], v[28:31], v[100:115]
  ds_read_b64_tr_b16 v[36:37], v13 offset:9216
  ds_read_b64_tr_b16 v[38:39], v13 offset:9472
  global_load_dwordx4 v[248:251], v3, s[4:5] offset:2048 sc1
  s_waitcnt lgkmcnt(2)
  v_mfma_f32_32x32x16_bf16 v[84:99], v[116:119], v[32:35], v[84:99]
  ds_read_b64_tr_b16 v[24:25], v12 offset:10240
  ds_read_b64_tr_b16 v[26:27], v12 offset:10496
  s_waitcnt lgkmcnt(2)
  v_mfma_f32_32x32x16_bf16 v[100:115], v[116:119], v[36:39], v[100:115]
  ds_read_b64_tr_b16 v[28:29], v13 offset:10240
  ds_read_b64_tr_b16 v[30:31], v13 offset:10496
  s_setprio 0
  s_waitcnt lgkmcnt(2)
  v_mfma_f32_32x32x16_bf16 v[84:99], v[120:123], v[24:27], v[84:99]
  ds_read_b64_tr_b16 v[32:33], v12 offset:11264
  ds_read_b64_tr_b16 v[34:35], v12 offset:11520
  s_waitcnt lgkmcnt(2)
  v_mfma_f32_32x32x16_bf16 v[100:115], v[120:123], v[28:31], v[100:115]
  ds_read_b64_tr_b16 v[36:37], v13 offset:11264
  ds_read_b64_tr_b16 v[38:39], v13 offset:11520
  global_load_dwordx4 v[252:255], v1, s[4:5] offset:2048 sc1
  s_waitcnt lgkmcnt(2)
  v_mfma_f32_32x32x16_bf16 v[84:99], v[124:127], v[32:35], v[84:99]
  ds_read_b64_tr_b16 v[24:25], v12 offset:12288
  ds_read_b64_tr_b16 v[26:27], v12 offset:12544
  s_waitcnt lgkmcnt(2)
  v_mfma_f32_32x32x16_bf16 v[100:115], v[124:127], v[36:39], v[100:115]
  ds_read_b64_tr_b16 v[28:29], v13 offset:12288
  ds_read_b64_tr_b16 v[30:31], v13 offset:12544
  global_load_dwordx4 v[208:211], v3, s[4:5] offset:3072 sc1
  s_setprio 3
  s_waitcnt lgkmcnt(2)
  v_mfma_f32_32x32x16_bf16 v[84:99], v[128:131], v[24:27], v[84:99]
  ds_read_b64_tr_b16 v[32:33], v12 offset:13312
  ds_read_b64_tr_b16 v[34:35], v12 offset:13568
  s_waitcnt lgkmcnt(2)
  v_mfma_f32_32x32x16_bf16 v[100:115], v[128:131], v[28:31], v[100:115]
  ds_read_b64_tr_b16 v[36:37], v13 offset:13312
  ds_read_b64_tr_b16 v[38:39], v13 offset:13568
  global_load_dwordx4 v[116:119], v1, s[4:5] offset:3072 sc1
  s_waitcnt lgkmcnt(2)
  v_mfma_f32_32x32x16_bf16 v[84:99], v[132:135], v[32:35], v[84:99]
  ds_read_b64_tr_b16 v[24:25], v12 offset:14336
  ds_read_b64_tr_b16 v[26:27], v12 offset:14592
  s_waitcnt lgkmcnt(2)
  v_mfma_f32_32x32x16_bf16 v[100:115], v[132:135], v[36:39], v[100:115]
  ds_read_b64_tr_b16 v[28:29], v13 offset:14336
  ds_read_b64_tr_b16 v[30:31], v13 offset:14592
  s_waitcnt vmcnt(6)
  s_barrier
  s_cmp_lg_u32 s33, 3
  s_cbranch_scc1 K3_fa
  s_mov_b64 exec, 1
  global_store_dword v18, v19, s[12:13] offset:0 sc1
  s_mov_b64 exec, -1
K3_fa:
  s_setprio 2
  s_waitcnt lgkmcnt(2)
  v_mfma_f32_32x32x16_bf16 v[84:99], v[136:139], v[24:27], v[84:99]
  ds_read_b64_tr_b16 v[32:33], v12 offset:15360
  ds_read_b64_tr_b16 v[34:35], v12 offset:15616
  s_waitcnt vmcnt(12)
  v_xor_b32 v20, s40, v45
  v_xor_b32 v21, s40, v49
  s_waitcnt lgkmcnt(2)
  v_mfma_f32_32x32x16_bf16 v[100:115], v[136:139], v[28:31], v[100:115]
  ds_read_b64_tr_b16 v[36:37], v13 offset:15360
  ds_read_b64_tr_b16 v[38:39], v13 offset:15616
  s_add_u32 s4, s4, 8192
  s_addc_u32 s5, s5, 0
  global_load_dwordx4 v[120:123], v3, s[4:5] offset:-4096 sc1
  v_or_b32 v20, v20, v21
  v_cmp_ne_u32 vcc, 0, v20
  s_waitcnt lgkmcnt(2)
  v_mfma_f32_32x32x16_bf16 v[84:99], v[140:143], v[32:35], v[84:99]
  ds_read_b64_tr_b16 v[24:25], v12 offset:16384
  ds_read_b64_tr_b16 v[26:27], v12 offset:16640
  s_cbranch_vccnz G_sr1
G_so1:
  v_mov_b32 v45, 0
  s_waitcnt lgkmcnt(2)
  v_mfma_f32_32x32x16_bf16 v[100:115], v[140:143], v[36:39], v[100:115]
  ds_read_b64_tr_b16 v[28:29], v13 offset:16384
  ds_read_b64_tr_b16 v[30:31], v13 offset:16640
  global_load_dwordx4 v[124:127], v1, s[4:5] offset:-4096 sc1
  v_mov_b32 v49, 0
  s_nop 1
  v_mfma_f32_32x32x16_bf16 v[100:115], v[192:195], v[48:51], v[100:115]
  v_mfma_f32_32x32x16_bf16 v[84:99], v[192:195], v[44:47], v[84:99]
  s_setprio 1
  s_waitcnt lgkmcnt(2)
  v_mfma_f32_32x32x16_bf16 v[84:99], v[144:147], v[24:27], v[84:99]
  ds_read_b64_tr_b16 v[32:33], v12 offset:17408
  ds_read_b64_tr_b16 v[34:35], v12 offset:17664
  s_waitcnt lgkmcnt(2)
  v_mfma_f32_32x32x16_bf16 v[100:115], v[144:147], v[28:31], v[100:115]
  ds_read_b64_tr_b16 v[36:37], v13 offset:17408
  ds_read_b64_tr_b16 v[38:39], v13 offset:17664
  global_load_dwordx4 v[128:131], v3, s[4:5] offset:-3072 sc1
  s_waitcnt lgkmcnt(2)
  v_mfma_f32_32x32x16_bf16 v[84:99], v[148:151], v[32:35], v[84:99]
  ds_read_b64_tr_b16 v[24:25], v12 offset:18432
  ds_read_b64_tr_b16 v[26:27], v12 offset:18688
  s_waitcnt lgkmcnt(2)
  v_mfma_f32_32x32x16_bf16 v[100:115], v[148:151], v[36:39], v[100:115]
  ds_read_b64_tr_b16 v[28:29], v13 offset:18432
  ds_read_b64_tr_b16 v[30:31], v13 offset:18688
  global_load_dwordx4 v[132:135], v1, s[4:5] offset:-3072 sc1
  s_setprio 0
  s_waitcnt lgkmcnt(2)
  v_mfma_f32_32x32x16_bf16 v[84:99], v[152:155], v[24:27], v[84:99]
  ds_read_b64_tr_b16 v[32:33], v12 offset:19456
  ds_read_b64_tr_b16 v[34:35], v12 offset:19712
  s_waitcnt lgkmcnt(2)
  v_mfma_f32_32x32x16_bf16 v[100:115], v[152:155], v[28:31], v[100:115]
  ds_read_b64_tr_b16 v[36:37], v13 offset:19456
  ds_read_b64_tr_b16 v[38:39], v13 offset:19712
  s_waitcnt lgkmcnt(2)
  v_mfma_f32_32x32x16_bf16 v[84:99], v[156:159], v[32:35], v[84:99]
  ds_read_b64_tr_b16 v[24:25], v12 offset:20480
  ds_read_b64_tr_b16 v[26:27], v12 offset:20736
  s_waitcnt lgkmcnt(2)
  v_mfma_f32_32x32x16_bf16 v[100:115], v[156:159], v[36:39], v[100:115]
  ds_read_b64_tr_b16 v[28:29], v13 offset:20480
  ds_read_b64_tr_b16 v[30:31], v13 offset:20736
  global_load_dwordx4 v[136:139], v3, s[4:5] offset:-2048 sc1
  s_setprio 3
  s_waitcnt lgkmcnt(2)
  v_mfma_f32_32x32x16_bf16 v[84:99], v[160:163], v[24:27], v[84:99]
  ds_read_b64_tr_b16 v[32:33], v12 offset:21504
  ds_read_b64_tr_b16 v[34:35], v12 offset:21760
  s_waitcnt lgkmcnt(2)
  v_mfma_f32_32x32x16_bf16 v[100:115], v[160:163], v[28:31], v[100:115]
  ds_read_b64_tr_b16 v[36:37], v13 offset:21504
  ds_read_b64_tr_b16 v[38:39], v13 offset:21760
  global_load_dwordx4 v[140:143], v1, s[4:5] offset:-2048 sc1
  s_waitcnt lgkmcnt(2)
  v_mfma_f32_32x32x16_bf16 v[84:99], v[164:167], v[32:35], v[84:99]
  ds_read_b64_tr_b16 v[24:25], v12 offset:22528
  ds_read_b64_tr_b16 v[26:27], v12 offset:22784
  s_waitcnt lgkmcnt(2)
  v_mfma_f32_32x32x16_bf16 v[100:115], v[164:167], v[36:39], v[100:115]
  ds_read_b64_tr_b16 v[28:29], v13 offset:22528
  ds_read_b64_tr_b16 v[30:31], v13 offset:22784
  global_load_dwordx4 v[144:147], v3, s[4:5] offset:-1024 sc1
  s_setprio 2
  s_waitcnt lgkmcnt(2)
  v_mfma_f32_32x32x16_bf16 v[84:99], v[168:171], v[24:27], v[84:99]
  ds_read_b64_tr_b16 v[32:33], v12 offset:23552
  ds_read_b64_tr_b16 v[34:35], v12 offset:23808
  s_waitcnt lgkmcnt(2)
  v_mfma_f32_32x32x16_bf16 v[100:115], v[168:171], v[28:31], v[100:115]
  ds_read_b64_tr_b16 v[36:37], v13 offset:23552
  ds_read_b64_tr_b16 v[38:39], v13 offset:23808
  s_waitcnt lgkmcnt(2)
  v_mfma_f32_32x32x16_bf16 v[84:99], v[172:175], v[32:35], v[84:99]
  ds_read_b64_tr_b16 v[24:25], v12 offset:24576
  ds_read_b64_tr_b16 v[26:27], v12 offset:24832
  s_waitcnt lgkmcnt(2)
  v_mfma_f32_32x32x16_bf16 v[100:115], v[172:175], v[36:39], v[100:115]
  ds_read_b64_tr_b16 v[28:29], v13 offset:24576
  ds_read_b64_tr_b16 v[30:31], v13 offset:24832
  global_load_dwordx4 v[148:151], v1, s[4:5] offset:-1024 sc1
  global_load_dword v15, v17, s[12:13] sc1
  s_setprio 1
  s_waitcnt lgkmcnt(2)
  v_mfma_f32_32x32x16_bf16 v[84:99], v[176:179], v[24:27], v[84:99]
  ds_read_b64_tr_b16 v[32:33], v12 offset:25600
  ds_read_b64_tr_b16 v[34:35], v12 offset:25856
  s_waitcnt lgkmcnt(2)
  v_mfma_f32_32x32x16_bf16 v[100:115], v[176:179], v[28:31], v[100:115]
  ds_read_b64_tr_b16 v[36:37], v13 offset:25600
  ds_read_b64_tr_b16 v[38:39], v13 offset:25856
  global_load_dwordx4 v[152:155], v3, s[4:5] offset:0 sc1
  s_waitcnt lgkmcnt(2)
  v_mfma_f32_32x32x16_bf16 v[84:99], v[180:183], v[32:35], v[84:99]
  ds_read_b64_tr_b16 v[24:25], v12 offset:26624
  ds_read_b64_tr_b16 v[26:27], v12 offset:26880
  s_waitcnt lgkmcnt(2)
  v_mfma_f32_32x32x16_bf16 v[100:115], v[180:183], v[36:39], v[100:115]
  ds_read_b64_tr_b16 v[28:29], v13 offset:26624
  ds_read_b64_tr_b16 v[30:31], v13 offset:26880
  global_load_dwordx4 v[156:159], v1, s[4:5] offset:0 sc1
  s_setprio 0
  s_waitcnt lgkmcnt(2)
  v_mfma_f32_32x32x16_bf16 v[84:99], v[184:187], v[24:27], v[84:99]
  ds_read_b64_tr_b16 v[32:33], v13 offset:27648
  ds_read_b64_tr_b16 v[34:35], v13 offset:27904
  s_waitcnt lgkmcnt(2)
  v_mfma_f32_32x32x16_bf16 v[100:115], v[184:187], v[28:31], v[100:115]
  ds_read_b64_tr_b16 v[36:37], v12 offset:27648
  ds_read_b64_tr_b16 v[38:39], v12 offset:27904
  s_waitcnt lgkmcnt(2)
  v_mfma_f32_32x32x16_bf16 v[100:115], v[188:191], v[32:35], v[100:115]
  s_waitcnt lgkmcnt(0)
  v_mfma_f32_32x32x16_bf16 v[84:99], v[188:191], v[36:39], v[84:99]
  s_cmp_lg_u32 s38, 0
  s_setprio 0
  s_nop 0
  s_cbranch_scc1 T_b
  v_cvt_pk_bf16_f32 v100, v100, v101
  v_cvt_pk_bf16_f32 v101, v102, v103
  v_cvt_pk_bf16_f32 v102, v104, v105
  v_cvt_pk_bf16_f32 v103, v106, v107
  v_pk_max_i16 v100, s72, v100
  v_pk_max_i16 v101, s72, v101
  v_pk_max_i16 v102, s72, v102
  v_pk_max_i16 v103, s72, v103
  ds_write_b128 v16, v[100:103] offset:49152
  v_cvt_pk_bf16_f32 v104, v108, v109
  v_cvt_pk_bf16_f32 v105, v110, v111
  v_cvt_pk_bf16_f32 v106, v112, v113
  v_cvt_pk_bf16_f32 v107, v114, v115
  v_pk_max_i16 v104, s72, v104
  v_pk_max_i16 v105, s72, v105
  v_pk_max_i16 v106, s72, v106
  v_pk_max_i16 v107, s72, v107
  ds_write_b128 v16, v[104:107] offset:50176
  v_max_f32 v84, 0, v84
  v_max_f32 v85, 0, v85
  v_max_f32 v86, 0, v86
  v_max_f32 v87, 0, v87
  v_max_f32 v88, 0, v88
  v_max_f32 v89, 0, v89
  v_max_f32 v90, 0, v90
  v_max_f32 v91, 0, v91
  v_max_f32 v92, 0, v92
  v_max_f32 v93, 0, v93
  v_max_f32 v94, 0, v94
  v_max_f32 v95, 0, v95
  v_max_f32 v96, 0, v96
  v_max_f32 v97, 0, v97
  v_max_f32 v98, 0, v98
  v_max_f32 v99, 0, v99
  v_and_b32 v4, 0x30, v2
  v_lshlrev_b32 v4, 1, v4
  v_add_u32 v10, s55, v8
  s_waitcnt vmcnt(2)
K3_pc0:
  v_cmp_ne_u32 vcc, s40, v15
  s_cbranch_vccnz K3_pr0
K3_po0:
  global_load_dwordx4 v[40:43], v3, s[8:9] offset:-4096 sc1
  global_load_dwordx4 v[192:195], v3, s[8:9] offset:-3072 sc1
  global_load_dwordx4 v[44:47], v3, s[8:9] offset:-2048 sc1
  global_load_dwordx4 v[48:51], v3, s[8:9] offset:-1024 sc1
  global_load_dwordx4 v[52:55], v3, s[8:9] offset:0 sc1
  s_waitcnt lgkmcnt(0)
  s_barrier
  ds_read_b128 v[108:111], v14 offset:49152
  ds_read_b128 v[112:115], v14 offset:50176
  s_waitcnt lgkmcnt(1)
  v_lshlrev_b32 v100, 16, v108
  v_and_b32 v101, 0xffff0000, v108
  v_lshlrev_b32 v102, 16, v109
  v_and_b32 v103, 0xffff0000, v109
  v_lshlrev_b32 v104, 16, v110
  v_and_b32 v105, 0xffff0000, v110
  v_lshlrev_b32 v106, 16, v111
  v_and_b32 v107, 0xffff0000, v111
  v_pk_mul_f32 v[84:85], v[84:85], v[100:101]
  v_pk_mul_f32 v[86:87], v[86:87], v[102:103]
  v_pk_mul_f32 v[88:89], v[88:89], v[104:105]
  v_pk_mul_f32 v[90:91], v[90:91], v[106:107]
  v_cvt_pk_bf16_f32 v84, v84, v85
  v_cvt_pk_bf16_f32 v85, v86, v87
  v_cvt_pk_bf16_f32 v86, v88, v89
  v_min_u32 v85, -2, v85
  v_cvt_pk_bf16_f32 v87, v90, v91
  global_store_dwordx4 v3, v[84:87], s[6:7] offset:0 sc1
  s_waitcnt lgkmcnt(0)
  v_lshlrev_b32 v100, 16, v112
  v_and_b32 v101, 0xffff0000, v112
  v_lshlrev_b32 v102, 16, v113
  v_and_b32 v103, 0xffff0000, v113
  v_lshlrev_b32 v104, 16, v114
  v_and_b32 v105, 0xffff0000, v114
  v_lshlrev_b32 v106, 16, v115
  v_and_b32 v107, 0xffff0000, v115
  ds_read_b64_tr_b16 v[108:109], v8 offset:0
  ds_read_b64_tr_b16 v[110:111], v8 offset:256
  ds_read_b64_tr_b16 v[112:113], v10 offset:0
  ds_read_b64_tr_b16 v[114:115], v10 offset:256
  v_pk_mul_f32 v[92:93], v[92:93], v[100:101]
  v_pk_mul_f32 v[94:95], v[94:95], v[102:103]
  v_pk_mul_f32 v[96:97], v[96:97], v[104:105]
  v_pk_mul_f32 v[98:99], v[98:99], v[106:107]
  v_cvt_pk_bf16_f32 v92, v92, v93
  v_cvt_pk_bf16_f32 v93, v94, v95
  v_cvt_pk_bf16_f32 v94, v96, v97
  v_min_u32 v93, -2, v93
  v_cvt_pk_bf16_f32 v95, v98, v99
  global_store_dwordx4 v3, v[92:95], s[6:7] offset:1024 sc1
  s_waitcnt lgkmcnt(0)
  s_barrier
  s_cmp_lg_u32 s33, 3
  s_cbranch_scc1 K3_fb
  s_mov_b64 exec, 1
  global_store_dword v18, v19, s[12:13] offset:128 sc1
  s_mov_b64 exec, -1
K3_fb:
  global_load_dwordx4 v[56:59], v3, s[8:9] offset:1024 sc1
  global_load_dwordx4 v[60:63], v3, s[8:9] offset:2048 sc1
  v_add_u32 v16, s49, v3
  v_mov_b32 v18, s54
  v_mov_b32 v19, 1
  s_waitcnt vmcnt(8)
  v_mfma_f32_32x32x16_bf16 v[24:39], v[200:203], v[40:43], 0
  v_mfma_f32_32x32x16_bf16 v[176:191], v[204:207], v[40:43], 0
  global_load_dwordx4 v[64:67], v3, s[8:9] offset:3072 sc1
  global_load_dwordx4 v[68:71], v3, s[10:11] offset:-4096 sc1
  s_waitcnt vmcnt(9)
  v_mfma_f32_32x32x16_bf16 v[24:39], v[196:199], v[192:195], v[24:39]
  v_mfma_f32_32x32x16_bf16 v[176:191], v[212:215], v[192:195], v[176:191]
  global_load_dwordx4 v[72:75], v3, s[10:11] offset:-3072 sc1
  global_load_dwordx4 v[76:79], v3, s[10:11] offset:-2048 sc1
  s_waitcnt vmcnt(10)
  v_mfma_f32_32x32x16_bf16 v[24:39], v[216:219], v[44:47], v[24:39]
  v_mfma_f32_32x32x16_bf16 v[176:191], v[220:223], v[44:47], v[176:191]
  global_load_dwordx4 v[80:83], v3, s[10:11] offset:-1024 sc1
  global_load_dwordx4 v[168:171], v3, s[10:11] offset:0 sc1
  s_waitcnt vmcnt(11)
  v_mfma_f32_32x32x16_bf16 v[24:39], v[224:227], v[48:51], v[24:39]
  v_mfma_f32_32x32x16_bf16 v[176:191], v[228:231], v[48:51], v[176:191]
  global_load_dwordx4 v[160:163], v3, s[4:5] offset:1024 sc1
  global_load_dwordx4 v[164:167], v1, s[4:5] offset:1024 sc1
  s_waitcnt vmcnt(12)
  v_mfma_f32_32x32x16_bf16 v[24:39], v[232:235], v[52:55], v[24:39]
  v_mfma_f32_32x32x16_bf16 v[176:191], v[236:239], v[52:55], v[176:191]
  global_load_dwordx4 v[172:175], v3, s[10:11] offset:1024 sc1
  s_waitcnt vmcnt(10)
  v_mfma_f32_32x32x16_bf16 v[24:39], v[240:243], v[56:59], v[24:39]
  v_mfma_f32_32x32x16_bf16 v[176:191], v[244:247], v[56:59], v[176:191]
  s_waitcnt vmcnt(9)
  v_mfma_f32_32x32x16_bf16 v[24:39], v[248:251], v[60:63], v[24:39]
  v_mfma_f32_32x32x16_bf16 v[176:191], v[252:255], v[60:63], v[176:191]
  s_waitcnt vmcnt(8)
  v_mfma_f32_32x32x16_bf16 v[24:39], v[208:211], v[64:67], v[24:39]
  v_mfma_f32_32x32x16_bf16 v[176:191], v[116:119], v[64:67], v[176:191]
  global_load_dword v9, v7, s[22:23] offset:1024 sc1
  global_load_dword v7, v7, s[22:23] sc1
  global_load_dwordx4 v[20:23], v4, s[16:17] sc1
  global_load_dwordx4 v[12:15], v4, s[16:17] offset:16 sc1
  s_waitcnt vmcnt(11)
  v_mfma_f32_32x32x16_bf16 v[24:39], v[120:123], v[68:71], v[24:39]
  v_mfma_f32_32x32x16_bf16 v[176:191], v[124:127], v[68:71], v[176:191]
  s_waitcnt vmcnt(10)
  v_mfma_f32_32x32x16_bf16 v[24:39], v[128:131], v[72:75], v[24:39]
  v_mfma_f32_32x32x16_bf16 v[176:191], v[132:135], v[72:75], v[176:191]
  s_waitcnt vmcnt(9)
  v_mfma_f32_32x32x16_bf16 v[24:39], v[136:139], v[76:79], v[24:39]
  v_mfma_f32_32x32x16_bf16 v[176:191], v[140:143], v[76:79], v[176:191]
  s_waitcnt vmcnt(8)
  v_mfma_f32_32x32x16_bf16 v[24:39], v[144:147], v[80:83], v[24:39]
  v_mfma_f32_32x32x16_bf16 v[176:191], v[148:151], v[80:83], v[176:191]
  s_waitcnt vmcnt(7)
  v_mfma_f32_32x32x16_bf16 v[24:39], v[152:155], v[168:171], v[24:39]
  v_mfma_f32_32x32x16_bf16 v[176:191], v[156:159], v[168:171], v[176:191]
  s_waitcnt vmcnt(4)
  v_mfma_f32_32x32x16_bf16 v[24:39], v[160:163], v[172:175], v[24:39]
  v_mfma_f32_32x32x16_bf16 v[176:191], v[164:167], v[172:175], v[176:191]
  s_nop 3
  ds_write_b128 v16, v[24:27] offset:0
  ds_write_b128 v16, v[28:31] offset:1024
  ds_write_b128 v16, v[32:35] offset:2048
  ds_write_b128 v16, v[36:39] offset:3072
  s_nop 3
  ds_write_b128 v16, v[176:179] offset:4096
  ds_write_b128 v16, v[180:183] offset:5120
  ds_write_b128 v16, v[184:187] offset:6144
  ds_write_b128 v16, v[188:191] offset:7168
  ds_write_b32 v18, v19
  v_add_u32 v16, 65536, v16
  global_load_dwordx4 v[40:43], v5, s[8:9] offset:-4096 sc1
  global_load_dwordx4 v[192:195], v5, s[8:9] offset:-3072 sc1
  global_load_dwordx4 v[44:47], v5, s[8:9] offset:-2048 sc1
  global_load_dwordx4 v[48:51], v5, s[8:9] offset:-1024 sc1
  global_load_dwordx4 v[52:55], v5, s[8:9] offset:0 sc1
  global_load_dwordx4 v[56:59], v5, s[8:9] offset:1024 sc1
  global_load_dwordx4 v[60:63], v5, s[8:9] offset:2048 sc1
  global_load_dwordx4 v[64:67], v5, s[8:9] offset:3072 sc1
  global_load_dwordx4 v[68:71], v5, s[10:11] offset:-4096 sc1
  global_load_dwordx4 v[72:75], v5, s[10:11] offset:-3072 sc1
  global_load_dwordx4 v[76:79], v5, s[10:11] offset:-2048 sc1
  global_load_dwordx4 v[80:83], v5, s[10:11] offset:-1024 sc1
  global_load_dwordx4 v[168:171], v5, s[10:11] offset:0 sc1
  global_load_dwordx4 v[172:175], v5, s[10:11] offset:1024 sc1
  s_waitcnt vmcnt(14)
  v_lshrrev_b32 v176, 1, v4
  v_add_u32 v176, s60, v176
  ds_read_b128 v[176:179], v176
  v_xor_b32 v21, s40, v21
  v_xor_b32 v23, s40, v23
  v_xor_b32 v13, s40, v13
  v_xor_b32 v15, s40, v15
  v_or3_b32 v21, v21, v23, v13
  v_or_b32 v21, v21, v15
  v_cmp_ne_u32 vcc, 0, v21
  s_cbranch_vccnz G_gr
G_gok:
  v_and_b32 v7, 0xffff0000, v7
  v_and_b32 v9, 0xffff0000, v9
  v_mul_f32 v7, v7, v7
  v_mul_f32 v9, v9, v9
  v_rcp_f32 v7, v7
  v_rcp_f32 v9, v9
  v_and_b32 v21, 0xffff0000, v20
  v_lshlrev_b32 v20, 16, v20
  v_and_b32 v23, 0xffff0000, v22
  v_lshlrev_b32 v22, 16, v22
  v_and_b32 v13, 0xffff0000, v12
  v_lshlrev_b32 v12, 16, v12
  v_and_b32 v15, 0xffff0000, v14
  v_lshlrev_b32 v14, 16, v14
  v_lshlrev_b32 v24, 16, v108
  v_and_b32 v25, 0xffff0000, v108
  v_lshlrev_b32 v26, 16, v109
  v_and_b32 v27, 0xffff0000, v109
  v_lshlrev_b32 v28, 16, v110
  v_and_b32 v29, 0xffff0000, v110
  v_lshlrev_b32 v30, 16, v111
  v_and_b32 v31, 0xffff0000, v111
  v_lshlrev_b32 v32, 16, v112
  v_and_b32 v33, 0xffff0000, v112
  v_lshlrev_b32 v34, 16, v113
  v_and_b32 v35, 0xffff0000, v113
  v_lshlrev_b32 v36, 16, v114
  v_and_b32 v37, 0xffff0000, v114
  v_lshlrev_b32 v38, 16, v115
  v_and_b32 v39, 0xffff0000, v115
  s_waitcnt lgkmcnt(0)
  v_lshlrev_b32 v180, 16, v176
  v_and_b32 v181, 0xffff0000, v176
  v_lshlrev_b32 v182, 16, v177
  v_and_b32 v183, 0xffff0000, v177
  v_lshlrev_b32 v184, 16, v178
  v_and_b32 v185, 0xffff0000, v178
  v_lshlrev_b32 v186, 16, v179
  v_and_b32 v187, 0xffff0000, v179
  v_rcp_f32 v180, v180
  v_rcp_f32 v181, v181
  v_rcp_f32 v182, v182
  v_rcp_f32 v183, v183
  v_rcp_f32 v184, v184
  v_rcp_f32 v185, v185
  v_rcp_f32 v186, v186
  v_rcp_f32 v187, v187
  v_pk_mul_f32 v[24:25], v[180:181], v[24:25]
  v_pk_mul_f32 v[26:27], v[182:183], v[26:27]
  v_pk_mul_f32 v[28:29], v[184:185], v[28:29]
  v_pk_mul_f32 v[30:31], v[186:187], v[30:31]
  v_pk_mul_f32 v[32:33], v[180:181], v[32:33]
  v_pk_mul_f32 v[34:35], v[182:183], v[34:35]
  v_pk_mul_f32 v[36:37], v[184:185], v[36:37]
  v_pk_mul_f32 v[38:39], v[186:187], v[38:39]
  v_pk_mul_f32 v[180:181], v[8:9], v[20:21] op_sel:[1,0]
  v_pk_mul_f32 v[182:183], v[8:9], v[22:23] op_sel:[1,0]
  v_pk_mul_f32 v[184:185], v[8:9], v[12:13] op_sel:[1,0]
  v_pk_mul_f32 v[186:187], v[8:9], v[14:15] op_sel:[1,0]
  v_pk_mul_f32 v[20:21], v[6:7], v[20:21] op_sel:[1,0]
  v_pk_mul_f32 v[22:23], v[6:7], v[22:23] op_sel:[1,0]
  v_pk_mul_f32 v[12:13], v[6:7], v[12:13] op_sel:[1,0]
  v_pk_mul_f32 v[14:15], v[6:7], v[14:15] op_sel:[1,0]
  s_waitcnt vmcnt(13)
  v_cmp_eq_u32 vcc, -1, v41
  s_cbranch_vccnz K_r014
K_o014:
  v_mfma_f32_32x32x16_bf16 v[84:99], v[200:203], v[40:43], 0
  s_waitcnt vmcnt(12)
  v_cmp_eq_u32 vcc, -1, v193
  v_mfma_f32_32x32x16_bf16 v[100:115], v[204:207], v[40:43], 0
  s_cbranch_vccnz K_r015
K_o015:
  v_mfma_f32_32x32x16_bf16 v[84:99], v[196:199], v[192:195], v[84:99]
  s_waitcnt vmcnt(11)
  v_cmp_eq_u32 vcc, -1, v45
  v_mfma_f32_32x32x16_bf16 v[100:115], v[212:215], v[192:195], v[100:115]
  s_cbranch_vccnz K_r016
K_o016:
  v_mfma_f32_32x32x16_bf16 v[84:99], v[216:219], v[44:47], v[84:99]
  s_waitcnt vmcnt(10)
  v_cmp_eq_u32 vcc, -1, v49
  v_mfma_f32_32x32x16_bf16 v[100:115], v[220:223], v[44:47], v[100:115]
  s_cbranch_vccnz K_r017
K_o017:
  v_mfma_f32_32x32x16_bf16 v[84:99], v[224:227], v[48:51], v[84:99]
  s_waitcnt vmcnt(9)
  v_cmp_eq_u32 vcc, -1, v53
  v_mfma_f32_32x32x16_bf16 v[100:115], v[228:231], v[48:51], v[100:115]
  s_cbranch_vccnz K_r018
K_o018:
  v_mfma_f32_32x32x16_bf16 v[84:99], v[232:235], v[52:55], v[84:99]
  s_waitcnt vmcnt(8)
  v_cmp_eq_u32 vcc, -1, v57
  v_mfma_f32_32x32x16_bf16 v[100:115], v[236:239], v[52:55], v[100:115]
  s_cbranch_vccnz K_r019
K_o019:
  v_mfma_f32_32x32x16_bf16 v[84:99], v[240:243], v[56:59], v[84:99]
  s_waitcnt vmcnt(7)
  v_cmp_eq_u32 vcc, -1, v61
  v_mfma_f32_32x32x16_bf16 v[100:115], v[244:247], v[56:59], v[100:115]
  s_cbranch_vccnz K_r020
K_o020:
  v_mfma_f32_32x32x16_bf16 v[84:99], v[248:251], v[60:63], v[84:99]
  s_waitcnt vmcnt(6)
  v_cmp_eq_u32 vcc, -1, v65
  v_mfma_f32_32x32x16_bf16 v[100:115], v[252:255], v[60:63], v[100:115]
  s_cbranch_vccnz K_r021
K_o021:
  v_mfma_f32_32x32x16_bf16 v[84:99], v[208:211], v[64:67], v[84:99]
  s_waitcnt vmcnt(5)
  v_cmp_eq_u32 vcc, -1, v69
  v_mfma_f32_32x32x16_bf16 v[100:115], v[116:119], v[64:67], v[100:115]
  s_cbranch_vccnz K_r022
K_o022:
  v_mfma_f32_32x32x16_bf16 v[84:99], v[120:123], v[68:71], v[84:99]
  s_waitcnt vmcnt(4)
  v_cmp_eq_u32 vcc, -1, v73
  v_mfma_f32_32x32x16_bf16 v[100:115], v[124:127], v[68:71], v[100:115]
  s_cbranch_vccnz K_r023
K_o023:
  v_mfma_f32_32x32x16_bf16 v[84:99], v[128:131], v[72:75], v[84:99]
  s_waitcnt vmcnt(3)
  v_cmp_eq_u32 vcc, -1, v77
  v_mfma_f32_32x32x16_bf16 v[100:115], v[132:135], v[72:75], v[100:115]
  s_cbranch_vccnz K_r024
K_o024:
  v_mfma_f32_32x32x16_bf16 v[84:99], v[136:139], v[76:79], v[84:99]
  s_waitcnt vmcnt(2)
  v_cmp_eq_u32 vcc, -1, v81
  v_mfma_f32_32x32x16_bf16 v[100:115], v[140:143], v[76:79], v[100:115]
  s_cbranch_vccnz K_r025
K_o025:
  v_mfma_f32_32x32x16_bf16 v[84:99], v[144:147], v[80:83], v[84:99]
  s_waitcnt vmcnt(1)
  v_cmp_eq_u32 vcc, -1, v169
  v_mfma_f32_32x32x16_bf16 v[100:115], v[148:151], v[80:83], v[100:115]
  s_cbranch_vccnz K_r026
K_o026:
  v_mfma_f32_32x32x16_bf16 v[84:99], v[152:155], v[168:171], v[84:99]
  s_waitcnt vmcnt(0)
  v_cmp_eq_u32 vcc, -1, v173
  v_mfma_f32_32x32x16_bf16 v[100:115], v[156:159], v[168:171], v[100:115]
  s_cbranch_vccnz K_r027
K_o027:
  v_mfma_f32_32x32x16_bf16 v[84:99], v[160:163], v[172:175], v[84:99]
  v_mfma_f32_32x32x16_bf16 v[100:115], v[164:167], v[172:175], v[100:115]
  s_nop 3
  ds_write_b128 v16, v[84:87] offset:0
  ds_write_b128 v16, v[88:91] offset:1024
  ds_write_b128 v16, v[92:95] offset:2048
  ds_write_b128 v16, v[96:99] offset:3072
  s_nop 3
  ds_write_b128 v16, v[100:103] offset:4096
  ds_write_b128 v16, v[104:107] offset:5120
  ds_write_b128 v16, v[108:111] offset:6144
  ds_write_b128 v16, v[112:115] offset:7168
  v_mov_b32 v19, 2
  v_and_b32 v1, 0x70, v3
  v_and_b32 v5, 0x30, v3
  ds_write_b32 v18, v19
  v_add_u32 v1, 162816, v1
  v_add_u32 v5, 162816, v5
T_1c:
  ds_read_b32 v2, v1
  s_waitcnt lgkmcnt(0)
  v_cmp_gt_u32 vcc, 1, v2
  s_cbranch_vccnz T_1c
  ds_read_b128 v[116:119], v0 offset:0
  ds_read_b128 v[120:123], v0 offset:2048
  ds_read_b128 v[124:127], v0 offset:8192
  ds_read_b128 v[128:131], v0 offset:10240
  ds_read_b128 v[132:135], v0 offset:16384
  ds_read_b128 v[136:139], v0 offset:18432
  ds_read_b128 v[140:143], v0 offset:24576
  ds_read_b128 v[144:147], v0 offset:26624
  ds_read_b128 v[148:151], v0 offset:32768
  ds_read_b128 v[152:155], v0 offset:34816
  ds_read_b128 v[156:159], v0 offset:40960
  ds_read_b128 v[160:163], v0 offset:43008
  ds_read_b128 v[164:167], v0 offset:49152
  ds_read_b128 v[168:171], v0 offset:51200
  ds_read_b128 v[172:175], v0 offset:57344
  ds_read_b128 v[176:179], v0 offset:59392
  v_add_u32 v0, 65536, v0
  s_waitcnt lgkmcnt(12)
  v_add_f32 v116, v116, v124
  v_add_f32 v117, v117, v125
  v_add_f32 v118, v118, v126
  v_add_f32 v119, v119, v127
  v_add_f32 v120, v120, v128
  v_add_f32 v121, v121, v129
  v_add_f32 v122, v122, v130
  v_add_f32 v123, v123, v131
  s_waitcnt lgkmcnt(10)
  v_add_f32 v116, v116, v132
  v_add_f32 v117, v117, v133
  v_add_f32 v118, v118, v134
  v_add_f32 v119, v119, v135
  v_add_f32 v120, v120, v136
  v_add_f32 v121, v121, v137
  v_add_f32 v122, v122, v138
  v_add_f32 v123, v123, v139
  s_waitcnt lgkmcnt(8)
  v_add_f32 v116, v116, v140
  v_add_f32 v117, v117, v141
  v_add_f32 v118, v118, v142
  v_add_f32 v119, v119, v143
  v_add_f32 v120, v120, v144
  v_add_f32 v121, v121, v145
  v_add_f32 v122, v122, v146
  v_add_f32 v123, v123, v147
  s_waitcnt lgkmcnt(6)
  v_add_f32 v116, v116, v148
  v_add_f32 v117, v117, v149
  v_add_f32 v118, v118, v150
  v_add_f32 v119, v119, v151
  v_add_f32 v120, v120, v152
  v_add_f32 v121, v121, v153
  v_add_f32 v122, v122, v154
  v_add_f32 v123, v123, v155
  s_waitcnt lgkmcnt(4)
  v_add_f32 v116, v116, v156
  v_add_f32 v117, v117, v157
  v_add_f32 v118, v118, v158
  v_add_f32 v119, v119, v159
  v_add_f32 v120, v120, v160
  v_add_f32 v121, v121, v161
  v_add_f32 v122, v122, v162
  v_add_f32 v123, v123, v163
  s_waitcnt lgkmcnt(2)
  v_add_f32 v116, v116, v164
  v_add_f32 v117, v117, v165
  v_add_f32 v118, v118, v166
  v_add_f32 v119, v119, v167
  v_add_f32 v120, v120, v168
  v_add_f32 v121, v121, v169
  v_add_f32 v122, v122, v170
  v_add_f32 v123, v123, v171
  s_waitcnt lgkmcnt(0)
  v_add_f32 v116, v116, v172
  v_add_f32 v117, v117, v173
  v_add_f32 v118, v118, v174
  v_add_f32 v119, v119, v175
  v_add_f32 v120, v120, v176
  v_add_f32 v121, v121, v177
  v_add_f32 v122, v122, v178
  v_add_f32 v123, v123, v179
  v_fma_f32 v24, v20, v116, v24
  v_fma_f32 v25, v21, v120, v25
  v_fma_f32 v26, v22, v117, v26
  v_fma_f32 v27, v23, v121, v27
  v_fma_f32 v28, v12, v118, v28
  v_fma_f32 v29, v13, v122, v29
  v_fma_f32 v30, v14, v119, v30
  v_fma_f32 v31, v15, v123, v31
  v_cvt_pk_bf16_f32 v240, v24, v25
  v_cvt_pk_bf16_f32 v241, v26, v27
  v_cvt_pk_bf16_f32 v242, v28, v29
  v_cvt_pk_bf16_f32 v243, v30, v31
  global_store_dwordx4 v6, v[240:243], s[62:63]
  v_add_u32 v6, 57344, v6
T_2c:
  ds_read_b32 v2, v5
  s_waitcnt lgkmcnt(0)
  v_cmp_gt_u32 vcc, 2, v2
  s_cbranch_vccnz T_2c
  ds_read_b128 v[116:119], v0 offset:0
  ds_read_b128 v[120:123], v0 offset:2048
  ds_read_b128 v[124:127], v0 offset:8192
  ds_read_b128 v[128:131], v0 offset:10240
  ds_read_b128 v[132:135], v0 offset:16384
  ds_read_b128 v[136:139], v0 offset:18432
  ds_read_b128 v[140:143], v0 offset:24576
  ds_read_b128 v[144:147], v0 offset:26624
  s_waitcnt lgkmcnt(4)
  v_add_f32 v116, v116, v124
  v_add_f32 v117, v117, v125
  v_add_f32 v118, v118, v126
  v_add_f32 v119, v119, v127
  v_add_f32 v120, v120, v128
  v_add_f32 v121, v121, v129
  v_add_f32 v122, v122, v130
  v_add_f32 v123, v123, v131
  s_waitcnt lgkmcnt(2)
  v_add_f32 v116, v116, v132
  v_add_f32 v117, v117, v133
  v_add_f32 v118, v118, v134
  v_add_f32 v119, v119, v135
  v_add_f32 v120, v120, v136
  v_add_f32 v121, v121, v137
  v_add_f32 v122, v122, v138
  v_add_f32 v123, v123, v139
  s_waitcnt lgkmcnt(0)
  v_add_f32 v116, v116, v140
  v_add_f32 v117, v117, v141
  v_add_f32 v118, v118, v142
  v_add_f32 v119, v119, v143
  v_add_f32 v120, v120, v144
  v_add_f32 v121, v121, v145
  v_add_f32 v122, v122, v146
  v_add_f32 v123, v123, v147
  s_barrier
  ds_read_b128 v[148:151], v0 offset:32768
  ds_read_b128 v[152:155], v0 offset:34816
  ds_read_b128 v[156:159], v0 offset:40960
  ds_read_b128 v[160:163], v0 offset:43008
  ds_read_b128 v[164:167], v0 offset:49152
  ds_read_b128 v[168:171], v0 offset:51200
  ds_read_b128 v[172:175], v0 offset:57344
  ds_read_b128 v[176:179], v0 offset:59392
  s_waitcnt lgkmcnt(6)
  v_pk_add_f32 v[116:117], v[116:117], v[148:149]
  v_pk_add_f32 v[118:119], v[118:119], v[150:151]
  v_pk_add_f32 v[120:121], v[120:121], v[152:153]
  v_pk_add_f32 v[122:123], v[122:123], v[154:155]
  s_waitcnt lgkmcnt(4)
  v_pk_add_f32 v[116:117], v[116:117], v[156:157]
  v_pk_add_f32 v[118:119], v[118:119], v[158:159]
  v_pk_add_f32 v[120:121], v[120:121], v[160:161]
  v_pk_add_f32 v[122:123], v[122:123], v[162:163]
  s_waitcnt lgkmcnt(2)
  v_pk_add_f32 v[116:117], v[116:117], v[164:165]
  v_pk_add_f32 v[118:119], v[118:119], v[166:167]
  v_pk_add_f32 v[120:121], v[120:121], v[168:169]
  v_pk_add_f32 v[122:123], v[122:123], v[170:171]
  s_waitcnt lgkmcnt(0)
  v_pk_add_f32 v[116:117], v[116:117], v[172:173]
  v_pk_add_f32 v[118:119], v[118:119], v[174:175]
  v_pk_add_f32 v[120:121], v[120:121], v[176:177]
  v_pk_add_f32 v[122:123], v[122:123], v[178:179]
  v_fma_f32 v32, v180, v116, v32
  v_fma_f32 v33, v181, v120, v33
  v_fma_f32 v34, v182, v117, v34
  v_fma_f32 v35, v183, v121, v35
  v_fma_f32 v36, v184, v118, v36
  v_fma_f32 v37, v185, v122, v37
  v_fma_f32 v38, v186, v119, v38
  v_fma_f32 v39, v187, v123, v39
  v_cvt_pk_bf16_f32 v244, v32, v33
  v_cvt_pk_bf16_f32 v245, v34, v35
  v_cvt_pk_bf16_f32 v246, v36, v37
  v_cvt_pk_bf16_f32 v247, v38, v39
  global_store_dwordx4 v6, v[244:247], s[62:63]
  s_endpgm
T_b:
  v_cvt_pk_bf16_f32 v100, v100, v101
  v_cvt_pk_bf16_f32 v101, v102, v103
  v_cvt_pk_bf16_f32 v102, v104, v105
  v_cvt_pk_bf16_f32 v103, v106, v107
  ds_write_b128 v16, v[100:103] offset:49152
  v_cvt_pk_bf16_f32 v104, v108, v109
  v_cvt_pk_bf16_f32 v105, v110, v111
  v_cvt_pk_bf16_f32 v106, v112, v113
  v_cvt_pk_bf16_f32 v107, v114, v115
  ds_write_b128 v16, v[104:107] offset:50176
  s_waitcnt lgkmcnt(0)
  s_barrier
  ds_read_b128 v[108:111], v14 offset:49152
  ds_read_b128 v[112:115], v14 offset:50176
  s_waitcnt vmcnt(2)
K3_pc1:
  v_cmp_ne_u32 vcc, s40, v15
  s_cbranch_vccnz K3_pr1
K3_po1:
  global_load_dwordx4 v[40:43], v3, s[8:9] offset:-4096 sc1
  global_load_dwordx4 v[192:195], v3, s[8:9] offset:-3072 sc1
  global_load_dwordx4 v[44:47], v3, s[8:9] offset:-2048 sc1
  global_load_dwordx4 v[48:51], v3, s[8:9] offset:-1024 sc1
  global_load_dwordx4 v[52:55], v3, s[8:9] offset:0 sc1
  s_waitcnt lgkmcnt(1)
  v_lshlrev_b32 v100, 16, v108
  v_and_b32 v101, 0xffff0000, v108
  v_lshlrev_b32 v102, 16, v109
  v_and_b32 v103, 0xffff0000, v109
  v_lshlrev_b32 v104, 16, v110
  v_and_b32 v105, 0xffff0000, v110
  v_lshlrev_b32 v106, 16, v111
  v_and_b32 v107, 0xffff0000, v111
  v_pk_mul_f32 v[84:85], v[84:85], v[100:101]
  v_pk_mul_f32 v[86:87], v[86:87], v[102:103]
  v_pk_mul_f32 v[88:89], v[88:89], v[104:105]
  v_pk_mul_f32 v[90:91], v[90:91], v[106:107]
  v_cvt_pk_bf16_f32 v84, v84, v85
  v_cvt_pk_bf16_f32 v85, v86, v87
  v_cvt_pk_bf16_f32 v86, v88, v89
  v_min_u32 v85, -2, v85
  v_cvt_pk_bf16_f32 v87, v90, v91
  global_store_dwordx4 v3, v[84:87], s[6:7] offset:0 sc1
  s_waitcnt lgkmcnt(0)
  v_lshlrev_b32 v100, 16, v112
  v_and_b32 v101, 0xffff0000, v112
  v_lshlrev_b32 v102, 16, v113
  v_and_b32 v103, 0xffff0000, v113
  v_lshlrev_b32 v104, 16, v114
  v_and_b32 v105, 0xffff0000, v114
  v_lshlrev_b32 v106, 16, v115
  v_and_b32 v107, 0xffff0000, v115
  v_pk_mul_f32 v[92:93], v[92:93], v[100:101]
  v_pk_mul_f32 v[94:95], v[94:95], v[102:103]
  v_pk_mul_f32 v[96:97], v[96:97], v[104:105]
  v_pk_mul_f32 v[98:99], v[98:99], v[106:107]
  v_cvt_pk_bf16_f32 v92, v92, v93
  v_cvt_pk_bf16_f32 v93, v94, v95
  v_cvt_pk_bf16_f32 v94, v96, v97
  v_min_u32 v93, -2, v93
  v_cvt_pk_bf16_f32 v95, v98, v99
  global_store_dwordx4 v3, v[92:95], s[6:7] offset:1024 sc1
  s_barrier
  global_load_dwordx4 v[56:59], v3, s[8:9] offset:1024 sc1
  global_load_dwordx4 v[60:63], v3, s[8:9] offset:2048 sc1
  v_add_u32 v16, s49, v3
  v_mov_b32 v18, s54
  v_mov_b32 v19, 1
  s_waitcnt vmcnt(8)
  v_mfma_f32_32x32x16_bf16 v[24:39], v[200:203], v[40:43], 0
  v_mfma_f32_32x32x16_bf16 v[176:191], v[204:207], v[40:43], 0
  global_load_dwordx4 v[64:67], v3, s[8:9] offset:3072 sc1
  global_load_dwordx4 v[68:71], v3, s[10:11] offset:-4096 sc1
  s_waitcnt vmcnt(9)
  v_mfma_f32_32x32x16_bf16 v[24:39], v[196:199], v[192:195], v[24:39]
  v_mfma_f32_32x32x16_bf16 v[176:191], v[212:215], v[192:195], v[176:191]
  global_load_dwordx4 v[72:75], v3, s[10:11] offset:-3072 sc1
  global_load_dwordx4 v[76:79], v3, s[10:11] offset:-2048 sc1
  s_waitcnt vmcnt(10)
  v_mfma_f32_32x32x16_bf16 v[24:39], v[216:219], v[44:47], v[24:39]
  v_mfma_f32_32x32x16_bf16 v[176:191], v[220:223], v[44:47], v[176:191]
  global_load_dwordx4 v[80:83], v3, s[10:11] offset:-1024 sc1
  global_load_dwordx4 v[168:171], v3, s[10:11] offset:0 sc1
  s_waitcnt vmcnt(11)
  v_mfma_f32_32x32x16_bf16 v[24:39], v[224:227], v[48:51], v[24:39]
  v_mfma_f32_32x32x16_bf16 v[176:191], v[228:231], v[48:51], v[176:191]
  global_load_dwordx4 v[160:163], v3, s[4:5] offset:1024 sc1
  global_load_dwordx4 v[164:167], v1, s[4:5] offset:1024 sc1
  s_waitcnt vmcnt(12)
  v_mfma_f32_32x32x16_bf16 v[24:39], v[232:235], v[52:55], v[24:39]
  v_mfma_f32_32x32x16_bf16 v[176:191], v[236:239], v[52:55], v[176:191]
  global_load_dwordx4 v[172:175], v3, s[10:11] offset:1024 sc1
  s_waitcnt vmcnt(10)
  v_mfma_f32_32x32x16_bf16 v[24:39], v[240:243], v[56:59], v[24:39]
  v_mfma_f32_32x32x16_bf16 v[176:191], v[244:247], v[56:59], v[176:191]
  s_waitcnt vmcnt(9)
  v_mfma_f32_32x32x16_bf16 v[24:39], v[248:251], v[60:63], v[24:39]
  v_mfma_f32_32x32x16_bf16 v[176:191], v[252:255], v[60:63], v[176:191]
  s_waitcnt vmcnt(8)
  v_mfma_f32_32x32x16_bf16 v[24:39], v[208:211], v[64:67], v[24:39]
  v_mfma_f32_32x32x16_bf16 v[176:191], v[116:119], v[64:67], v[176:191]
  s_waitcnt vmcnt(7)
  v_mfma_f32_32x32x16_bf16 v[24:39], v[120:123], v[68:71], v[24:39]
  v_mfma_f32_32x32x16_bf16 v[176:191], v[124:127], v[68:71], v[176:191]
  s_waitcnt vmcnt(6)
  v_mfma_f32_32x32x16_bf16 v[24:39], v[128:131], v[72:75], v[24:39]
  v_mfma_f32_32x32x16_bf16 v[176:191], v[132:135], v[72:75], v[176:191]
  s_waitcnt vmcnt(5)
  v_mfma_f32_32x32x16_bf16 v[24:39], v[136:139], v[76:79], v[24:39]
  v_mfma_f32_32x32x16_bf16 v[176:191], v[140:143], v[76:79], v[176:191]
  s_waitcnt vmcnt(4)
  v_mfma_f32_32x32x16_bf16 v[24:39], v[144:147], v[80:83], v[24:39]
  v_mfma_f32_32x32x16_bf16 v[176:191], v[148:151], v[80:83], v[176:191]
  s_waitcnt vmcnt(3)
  v_mfma_f32_32x32x16_bf16 v[24:39], v[152:155], v[168:171], v[24:39]
  v_mfma_f32_32x32x16_bf16 v[176:191], v[156:159], v[168:171], v[176:191]
  s_waitcnt vmcnt(0)
  v_mfma_f32_32x32x16_bf16 v[24:39], v[160:163], v[172:175], v[24:39]
  v_mfma_f32_32x32x16_bf16 v[176:191], v[164:167], v[172:175], v[176:191]
  s_nop 3
  ds_write_b128 v16, v[24:27] offset:0
  ds_write_b128 v16, v[28:31] offset:1024
  ds_write_b128 v16, v[32:35] offset:2048
  ds_write_b128 v16, v[36:39] offset:3072
  s_nop 3
  ds_write_b128 v16, v[176:179] offset:4096
  ds_write_b128 v16, v[180:183] offset:5120
  ds_write_b128 v16, v[184:187] offset:6144
  ds_write_b128 v16, v[188:191] offset:7168
  ds_write_b32 v18, v19
  v_add_u32 v16, 65536, v16
  global_load_dwordx4 v[40:43], v5, s[8:9] offset:-4096 sc1
  global_load_dwordx4 v[192:195], v5, s[8:9] offset:-3072 sc1
  global_load_dwordx4 v[44:47], v5, s[8:9] offset:-2048 sc1
  global_load_dwordx4 v[48:51], v5, s[8:9] offset:-1024 sc1
  global_load_dwordx4 v[52:55], v5, s[8:9] offset:0 sc1
  global_load_dwordx4 v[56:59], v5, s[8:9] offset:1024 sc1
  global_load_dwordx4 v[60:63], v5, s[8:9] offset:2048 sc1
  global_load_dwordx4 v[64:67], v5, s[8:9] offset:3072 sc1
  global_load_dwordx4 v[68:71], v5, s[10:11] offset:-4096 sc1
  global_load_dwordx4 v[72:75], v5, s[10:11] offset:-3072 sc1
  global_load_dwordx4 v[76:79], v5, s[10:11] offset:-2048 sc1
  global_load_dwordx4 v[80:83], v5, s[10:11] offset:-1024 sc1
  global_load_dwordx4 v[168:171], v5, s[10:11] offset:0 sc1
  global_load_dwordx4 v[172:175], v5, s[10:11] offset:1024 sc1
  s_waitcnt vmcnt(13)
  v_cmp_eq_u32 vcc, -1, v41
  s_cbranch_vccnz K_r114
K_o114:
  v_mfma_f32_32x32x16_bf16 v[84:99], v[200:203], v[40:43], 0
  s_waitcnt vmcnt(12)
  v_cmp_eq_u32 vcc, -1, v193
  v_mfma_f32_32x32x16_bf16 v[100:115], v[204:207], v[40:43], 0
  s_cbranch_vccnz K_r115
K_o115:
  v_mfma_f32_32x32x16_bf16 v[84:99], v[196:199], v[192:195], v[84:99]
  s_waitcnt vmcnt(11)
  v_cmp_eq_u32 vcc, -1, v45
  v_mfma_f32_32x32x16_bf16 v[100:115], v[212:215], v[192:195], v[100:115]
  s_cbranch_vccnz K_r116
K_o116:
  v_mfma_f32_32x32x16_bf16 v[84:99], v[216:219], v[44:47], v[84:99]
  s_waitcnt vmcnt(10)
  v_cmp_eq_u32 vcc, -1, v49
  v_mfma_f32_32x32x16_bf16 v[100:115], v[220:223], v[44:47], v[100:115]
  s_cbranch_vccnz K_r117
K_o117:
  v_mfma_f32_32x32x16_bf16 v[84:99], v[224:227], v[48:51], v[84:99]
  s_waitcnt vmcnt(9)
  v_cmp_eq_u32 vcc, -1, v53
  v_mfma_f32_32x32x16_bf16 v[100:115], v[228:231], v[48:51], v[100:115]
  s_cbranch_vccnz K_r118
K_o118:
  v_mfma_f32_32x32x16_bf16 v[84:99], v[232:235], v[52:55], v[84:99]
  s_waitcnt vmcnt(8)
  v_cmp_eq_u32 vcc, -1, v57
  v_mfma_f32_32x32x16_bf16 v[100:115], v[236:239], v[52:55], v[100:115]
  s_cbranch_vccnz K_r119
K_o119:
  v_mfma_f32_32x32x16_bf16 v[84:99], v[240:243], v[56:59], v[84:99]
  s_waitcnt vmcnt(7)
  v_cmp_eq_u32 vcc, -1, v61
  v_mfma_f32_32x32x16_bf16 v[100:115], v[244:247], v[56:59], v[100:115]
  s_cbranch_vccnz K_r120
K_o120:
  v_mfma_f32_32x32x16_bf16 v[84:99], v[248:251], v[60:63], v[84:99]
  s_waitcnt vmcnt(6)
  v_cmp_eq_u32 vcc, -1, v65
  v_mfma_f32_32x32x16_bf16 v[100:115], v[252:255], v[60:63], v[100:115]
  s_cbranch_vccnz K_r121
K_o121:
  v_mfma_f32_32x32x16_bf16 v[84:99], v[208:211], v[64:67], v[84:99]
  s_waitcnt vmcnt(5)
  v_cmp_eq_u32 vcc, -1, v69
  v_mfma_f32_32x32x16_bf16 v[100:115], v[116:119], v[64:67], v[100:115]
  s_cbranch_vccnz K_r122
K_o122:
  v_mfma_f32_32x32x16_bf16 v[84:99], v[120:123], v[68:71], v[84:99]
  s_waitcnt vmcnt(4)
  v_cmp_eq_u32 vcc, -1, v73
  v_mfma_f32_32x32x16_bf16 v[100:115], v[124:127], v[68:71], v[100:115]
  s_cbranch_vccnz K_r123
K_o123:
  v_mfma_f32_32x32x16_bf16 v[84:99], v[128:131], v[72:75], v[84:99]
  s_waitcnt vmcnt(3)
  v_cmp_eq_u32 vcc, -1, v77
  v_mfma_f32_32x32x16_bf16 v[100:115], v[132:135], v[72:75], v[100:115]
  s_cbranch_vccnz K_r124
K_o124:
  v_mfma_f32_32x32x16_bf16 v[84:99], v[136:139], v[76:79], v[84:99]
  s_waitcnt vmcnt(2)
  v_cmp_eq_u32 vcc, -1, v81
  v_mfma_f32_32x32x16_bf16 v[100:115], v[140:143], v[76:79], v[100:115]
  s_cbranch_vccnz K_r125
K_o125:
  v_mfma_f32_32x32x16_bf16 v[84:99], v[144:147], v[80:83], v[84:99]
  s_waitcnt vmcnt(1)
  v_cmp_eq_u32 vcc, -1, v169
  s_cbranch_vccnz K_r126
K_o126:
  v_mfma_f32_32x32x16_bf16 v[84:99], v[152:155], v[168:171], v[84:99]
  s_waitcnt vmcnt(0)
  v_cmp_eq_u32 vcc, -1, v173
  s_cbranch_vccnz K_r127
K_o127:
  v_mfma_f32_32x32x16_bf16 v[84:99], v[160:163], v[172:175], v[84:99]
  v_mfma_f32_32x32x16_bf16 v[100:115], v[148:151], v[80:83], v[100:115]
  v_mfma_f32_32x32x16_bf16 v[100:115], v[156:159], v[168:171], v[100:115]
  ds_write_b128 v16, v[84:87] offset:0
  v_mfma_f32_32x32x16_bf16 v[100:115], v[164:167], v[172:175], v[100:115]
  ds_write_b128 v16, v[88:91] offset:1024
  ds_write_b128 v16, v[92:95] offset:2048
  ds_write_b128 v16, v[96:99] offset:3072
  s_nop 8
  ds_write_b128 v16, v[100:103] offset:4096
  ds_write_b128 v16, v[104:107] offset:5120
  ds_write_b128 v16, v[108:111] offset:6144
  ds_write_b128 v16, v[112:115] offset:7168
  s_waitcnt lgkmcnt(0)
  s_barrier
  s_endpgm
F_prep:
  s_lshl_b32 s3, s70, 6
  s_add_u32 s3, s3, 401408
  s_add_u32 s36, s44, s3
  s_addc_u32 s37, s45, 0
  s_setprio 3
  s_waitcnt lgkmcnt(0)
  s_barrier
  s_cmp_eq_u32 s33, 7
  s_cbranch_scc1 F_ep
F_ep1:
  s_add_u32 m0, s50, 134272
  s_add_u32 s64, s64, 57344
  s_addc_u32 s65, s65, 0
  global_load_lds_dwordx4 v223, s[64:65]
  s_add_u32 m0, s50, 130176
  s_add_u32 s64, s64, 57344
  s_addc_u32 s65, s65, 0
  global_load_lds_dwordx4 v223, s[64:65]
  s_add_u32 m0, s50, 46400
  s_add_u32 s64, s64, 57344
  s_addc_u32 s65, s65, 0
  global_load_lds_dwordx4 v223, s[64:65]
  s_add_u32 m0, s50, 50496
  s_add_u32 s64, s64, 57344
  s_addc_u32 s65, s65, 0
  global_load_lds_dwordx4 v223, s[64:65]
  s_add_u32 m0, s50, 76928
  s_add_u32 s64, s64, 57344
  s_addc_u32 s65, s65, 0
  global_load_lds_dwordx4 v223, s[64:65]
  ds_read_b64_tr_b16 v[224:225], v20 offset:16384
  ds_read_b64_tr_b16 v[226:227], v20 offset:16640
  s_add_u32 m0, s50, 126080
  s_add_u32 s64, s64, 57344
  s_addc_u32 s65, s65, 0
  global_load_lds_dwordx4 v223, s[64:65]
  ds_read_b64_tr_b16 v[228:229], v20 offset:20480
  ds_read_b64_tr_b16 v[230:231], v20 offset:20736
  global_load_dwordx4 v[40:43], v220, s[20:21] sc1
  s_add_u32 m0, s50, 81024
  s_add_u32 s64, s64, 57344
  s_addc_u32 s65, s65, 0
  global_load_lds_dwordx4 v223, s[64:65]
  s_waitcnt vmcnt(13)
  ds_read_b64_tr_b16 v[232:233], v1 offset:21824
  ds_read_b64_tr_b16 v[234:235], v1 offset:22080
  v_lshrrev_b32 v24, 5, v2
  v_bfe_u32 v31, v2, 3, 1
  v_mul_u32_u24 v31, 87360, v31
  v_sub_u32 v31, 162944, v31
  v_lshl_add_u32 v21, v24, 4, v31
  s_mov_b32 s18, 0xf0f00f0f
  s_mov_b32 s19, 0xf0f00f0f
  v_mov_b32 v31, 0x30000
  v_cndmask_b32 v21, v31, v21, s[18:19]
  s_and_b32 s3, s35, 1
  s_lshl2_add_u32 s3, s3, 125920
  v_mov_b32 v27, s3
  s_lshl2_add_u32 s3, s35, 162944
  v_mov_b32 v26, s3
  s_lshl_b32 s3, s66, 11
  s_add_u32 s3, s3, 65536
  v_and_b32 v22, 15, v2
  v_lshl_add_u32 v22, v22, 7, s3
  s_add_u32 m0, s50, 85120
  s_add_u32 s64, s64, 57344
  s_addc_u32 s65, s65, 0
  global_load_lds_dwordx4 v223, s[64:65]
  s_waitcnt vmcnt(13)
  ds_read_b64_tr_b16 v[236:237], v1 offset:25920
  ds_read_b64_tr_b16 v[238:239], v1 offset:26176
  s_add_u32 m0, s50, 89216
  s_add_u32 s36, s36, 57344
  s_addc_u32 s37, s37, 0
  global_load_lds_dwordx4 v223, s[36:37]
  s_waitcnt vmcnt(13)
  ds_read_b64_tr_b16 v[240:241], v1 offset:30016
  ds_read_b64_tr_b16 v[242:243], v1 offset:30272
  s_add_u32 m0, s50, 93312
  s_add_u32 s36, s36, 57344
  s_addc_u32 s37, s37, 0
  global_load_lds_dwordx4 v223, s[36:37]
  s_waitcnt vmcnt(13)
  ds_read_b64_tr_b16 v[244:245], v1 offset:34112
  ds_read_b64_tr_b16 v[246:247], v1 offset:34368
  s_waitcnt lgkmcnt(6)
  s_add_u32 m0, s50, 21824
  s_add_u32 s64, s64, 57344
  s_addc_u32 s65, s65, 0
  global_load_lds_dwordx4 v223, s[64:65]
  s_waitcnt vmcnt(13)
  ds_read_b64_tr_b16 v[248:249], v1 offset:38208
  ds_read_b64_tr_b16 v[250:251], v1 offset:38464
  s_waitcnt lgkmcnt(6)
  s_add_u32 m0, s50, 25920
  s_add_u32 s64, s64, 57344
  s_addc_u32 s65, s65, 0
  global_load_lds_dwordx4 v223, s[64:65]
  s_waitcnt vmcnt(13)
  ds_read_b64_tr_b16 v[252:253], v1 offset:42304
  ds_read_b64_tr_b16 v[254:255], v1 offset:42560
  s_add_u32 m0, s50, 97408
  s_add_u32 s64, s64, 57344
  s_addc_u32 s65, s65, 0
  global_load_lds_dwordx4 v223, s[64:65]
  s_waitcnt vmcnt(13)
  ds_read_b64_tr_b16 v[208:209], v18 offset:57344
  ds_read_b64_tr_b16 v[210:211], v18 offset:57600
  s_add_u32 m0, s50, 101504
  s_add_u32 s64, s64, 57344
  s_addc_u32 s65, s65, 0
  global_load_lds_dwordx4 v223, s[64:65]
  s_waitcnt vmcnt(13)
  ds_read_b64_tr_b16 v[116:117], v18 offset:53248
  ds_read_b64_tr_b16 v[118:119], v18 offset:53504
  s_add_u32 m0, s50, 105600
  s_add_u32 s64, s64, 57344
  s_addc_u32 s65, s65, 0
  global_load_lds_dwordx4 v223, s[64:65]
  s_waitcnt vmcnt(13)
  ds_read_b64_tr_b16 v[120:121], v1 offset:46400
  ds_read_b64_tr_b16 v[122:123], v1 offset:46656
  s_waitcnt lgkmcnt(4)
  s_add_u32 m0, s50, 134272
  s_add_u32 s64, s64, 57344
  s_addc_u32 s65, s65, 0
  global_load_lds_dwordx4 v223, s[64:65]
  s_waitcnt vmcnt(13)
  ds_read_b64_tr_b16 v[124:125], v1 offset:50496
  ds_read_b64_tr_b16 v[126:127], v1 offset:50752
  s_waitcnt lgkmcnt(4)
  s_add_u32 m0, s50, 130176
  s_add_u32 s64, s64, 57344
  s_addc_u32 s65, s65, 0
  global_load_lds_dwordx4 v223, s[64:65]
  s_waitcnt vmcnt(13)
  ds_read_b64_tr_b16 v[128:129], v18 offset:0
  ds_read_b64_tr_b16 v[130:131], v18 offset:256
  s_add_u32 m0, s50, 150656
  s_add_u32 s64, s64, 57344
  s_addc_u32 s65, s65, 0
  global_load_lds_dwordx4 v223, s[64:65]
  s_waitcnt vmcnt(12)
F_chk2:
  v_xor_b32 v41, s40, v41
  v_xor_b32 v43, s40, v43
  v_or_b32 v24, v41, v43
  v_cmp_ne_u32 vcc, 0, v24
  s_cbranch_vccnz F_rt4
F_ok2:
  ds_write2_b32 v222, v40, v42 offset0:0 offset1:1
  s_waitcnt vmcnt(8)
  global_load_dword v23, v22, s[20:21] sc1
  s_branch F_b4
G_xb:
  s_waitcnt vmcnt(1)
G_fc:
  v_cmp_ne_u32 vcc, s40, v23
  s_cbranch_vccnz G_fr
G_fo:
  s_lshr_b32 s3, s69, 1
  s_xor_b32 s24, s33, 4
  s_or_b32 s3, s3, s24
  s_cbranch_scc0 G_sg
G_sg1:
  s_and_b32 s45, s33, 1
  s_cselect_b32 s46, 0, 109696
  s_lshr_b32 s47, s33, 1
  s_lshl_b32 s26, s47, 10
  s_add_u32 s26, s26, s46
  s_mul_i32 s27, s47, -3072
  s_sub_u32 s27, s27, 114688
  s_lshl_b32 s44, s66, 2
  s_add_u32 s44, s44, s45
  s_mul_i32 s44, s44, 57344
  s_mul_i32 s28, s47, 3584
  s_add_u32 s29, s28, s44
  s_add_u32 s29, s29, 21086208
  v_and_b32 v15, 7, v2
  v_lshl_add_u32 v15, v15, 4, s29
  v_lshrrev_b32 v6, 4, v2
  v_lshl_add_u32 v15, v6, 7, v15
  v_bfe_u32 v6, v2, 3, 1
  v_mul_u32_u24 v6, 28672, v6
  v_add_u32 v15, v15, v6
  s_lshl_b32 s28, s28, 1
  s_mul_i32 s46, s45, 28672
  s_add_u32 s28, s28, s46
  s_add_u32 s28, s28, 28672
  v_add3_u32 v14, s26, v3, 0
  v_lshrrev_b32 v6, 5, v2
  v_lshlrev_b32 v5, 9, v6
  v_bfe_u32 v7, v2, 3, 1
  v_lshl_add_u32 v5, v7, 6, v5
  v_bfe_u32 v8, v2, 4, 1
  v_lshl_add_u32 v5, v8, 7, v5
  v_and_b32 v7, 3, v2
  v_lshl_add_u32 v5, v7, 4, v5
  v_and_b32 v9, 4, v2
  v_lshl_add_u32 v5, v9, 1, v5
  s_cmp_eq_u32 s38, 0
  s_cselect_b32 s46, 109696, 0
  s_cselect_b32 s44, 0, 109696
  s_mul_i32 s52, s38, 138368
  v_add_u32 v12, s46, v5
  v_add_u32 v13, s44, v5
  s_sub_u32 s53, 57344, s52
  s_sub_u32 s52, s52, 81024
  ds_read_b64_tr_b16 v[132:133], v18 offset:49152
  ds_read_b64_tr_b16 v[134:135], v18 offset:49408
  ds_read_b64_tr_b16 v[136:137], v18 offset:4096
  ds_read_b64_tr_b16 v[138:139], v18 offset:4352
  ds_read_b64_tr_b16 v[140:141], v18 offset:8192
  ds_read_b64_tr_b16 v[142:143], v18 offset:8448
  ds_read_b64_tr_b16 v[144:145], v1 offset:21824
  ds_read_b64_tr_b16 v[146:147], v1 offset:22080
  ds_read_b64_tr_b16 v[148:149], v1 offset:25920
  ds_read_b64_tr_b16 v[150:151], v1 offset:26176
  ds_read_b64_tr_b16 v[152:153], v18 offset:20480
  ds_read_b64_tr_b16 v[154:155], v18 offset:20736
  ds_read_b64_tr_b16 v[156:157], v18 offset:24576
  ds_read_b64_tr_b16 v[158:159], v18 offset:24832
  ds_read_b64_tr_b16 v[160:161], v18 offset:28672
  ds_read_b64_tr_b16 v[162:163], v18 offset:28928
  ds_read_b64_tr_b16 v[164:165], v18 offset:57344
  ds_read_b64_tr_b16 v[166:167], v18 offset:57600
  ds_read_b64_tr_b16 v[168:169], v18 offset:53248
  ds_read_b64_tr_b16 v[170:171], v18 offset:53504
  ds_read_b64_tr_b16 v[172:173], v20 offset:12288
  ds_read_b64_tr_b16 v[174:175], v20 offset:12544
  ds_read_b128 v[44:47], v21 offset:0
  ds_read_b128 v[48:51], v21 offset:32
  ds_read_b128 v[52:55], v21 offset:64
  ds_read_b128 v[56:59], v21 offset:96
  ds_read_b128 v[60:63], v21 offset:128
  ds_read_b128 v[64:67], v21 offset:160
  ds_read_b128 v[68:71], v21 offset:192
  ds_read_b128 v[72:75], v21 offset:224
  ds_read_b128 v[96:99], v21 offset:768
  ds_read_b128 v[100:103], v21 offset:800
  ds_read_b128 v[104:107], v21 offset:832
  ds_read_b128 v[108:111], v21 offset:864
  s_waitcnt lgkmcnt(10)
  v_mfma_f32_16x16x32_bf16 v[92:95], v[44:47], v[224:227], 0
  v_mfma_f32_16x16x32_bf16 v[92:95], v[48:51], v[228:231], v[92:95]
  ds_read_b128 v[44:47], v21 offset:256
  ds_read_b128 v[48:51], v21 offset:288
  s_waitcnt lgkmcnt(10)
  v_mfma_f32_16x16x32_bf16 v[92:95], v[52:55], v[232:235], v[92:95]
  v_mfma_f32_16x16x32_bf16 v[92:95], v[56:59], v[236:239], v[92:95]
  ds_read_b128 v[52:55], v21 offset:320
  ds_read_b128 v[56:59], v21 offset:352
  s_waitcnt lgkmcnt(10)
  v_mfma_f32_16x16x32_bf16 v[92:95], v[60:63], v[240:243], v[92:95]
  v_mfma_f32_16x16x32_bf16 v[92:95], v[64:67], v[244:247], v[92:95]
  ds_read_b128 v[60:63], v21 offset:384
  ds_read_b128 v[64:67], v21 offset:416
  s_waitcnt lgkmcnt(10)
  v_mfma_f32_16x16x32_bf16 v[92:95], v[68:71], v[248:251], v[92:95]
  v_mfma_f32_16x16x32_bf16 v[92:95], v[72:75], v[252:255], v[92:95]
  ds_read_b128 v[68:71], v21 offset:448
  ds_read_b128 v[72:75], v21 offset:480
  s_waitcnt lgkmcnt(6)
  v_mfma_f32_16x16x32_bf16 v[92:95], v[44:47], v[208:211], v[92:95]
  v_mfma_f32_16x16x32_bf16 v[92:95], v[48:51], v[116:119], v[92:95]
  ds_read_b128 v[44:47], v21 offset:512
  ds_read_b128 v[48:51], v21 offset:544
  s_waitcnt lgkmcnt(6)
  v_mfma_f32_16x16x32_bf16 v[92:95], v[52:55], v[120:123], v[92:95]
  v_mfma_f32_16x16x32_bf16 v[92:95], v[56:59], v[124:127], v[92:95]
  ds_read_b128 v[52:55], v21 offset:576
  ds_read_b128 v[56:59], v21 offset:608
  s_waitcnt lgkmcnt(6)
  v_mfma_f32_16x16x32_bf16 v[92:95], v[60:63], v[128:131], v[92:95]
  v_mfma_f32_16x16x32_bf16 v[92:95], v[64:67], v[132:135], v[92:95]
  ds_read_b128 v[60:63], v21 offset:640
  ds_read_b128 v[64:67], v21 offset:672
  s_waitcnt lgkmcnt(6)
  v_mfma_f32_16x16x32_bf16 v[92:95], v[68:71], v[136:139], v[92:95]
  v_mfma_f32_16x16x32_bf16 v[92:95], v[72:75], v[140:143], v[92:95]
  ds_read_b128 v[68:71], v21 offset:704
  ds_read_b128 v[72:75], v21 offset:736
  s_waitcnt lgkmcnt(6)
  v_mfma_f32_16x16x32_bf16 v[92:95], v[44:47], v[144:147], v[92:95]
  v_mfma_f32_16x16x32_bf16 v[92:95], v[48:51], v[148:151], v[92:95]
  s_waitcnt lgkmcnt(4)
  v_mfma_f32_16x16x32_bf16 v[92:95], v[52:55], v[152:155], v[92:95]
  v_mfma_f32_16x16x32_bf16 v[92:95], v[56:59], v[156:159], v[92:95]
  s_waitcnt lgkmcnt(2)
  v_mfma_f32_16x16x32_bf16 v[92:95], v[60:63], v[160:163], v[92:95]
  v_mfma_f32_16x16x32_bf16 v[92:95], v[64:67], v[164:167], v[92:95]
  s_waitcnt lgkmcnt(0)
  v_mfma_f32_16x16x32_bf16 v[92:95], v[68:71], v[168:171], v[92:95]
  v_mfma_f32_16x16x32_bf16 v[92:95], v[72:75], v[172:175], v[92:95]
  s_barrier
  v_add_u32 v4, s27, v15
  s_add_u32 m0, s26, 0
  s_nop 0
  global_load_lds_dwordx4 v4, s[20:21] offset:0 sc1
  s_add_u32 m0, s26, 2048
  s_nop 0
  global_load_lds_dwordx4 v4, s[20:21] offset:2048 sc1
  s_add_u32 m0, s26, 8192
  v_add_u32 v4, 4096, v4
  global_load_lds_dwordx4 v4, s[20:21] offset:0 sc1
  s_add_u32 m0, s26, 10240
  s_nop 0
  global_load_lds_dwordx4 v4, s[20:21] offset:2048 sc1
  s_add_u32 m0, s26, 16384
  v_add_u32 v4, 4096, v4
  global_load_lds_dwordx4 v4, s[20:21] offset:0 sc1
  s_add_u32 m0, s26, 18432
  s_nop 0
  global_load_lds_dwordx4 v4, s[20:21] offset:2048 sc1
  s_add_u32 m0, s26, 24576
  v_add_u32 v4, 4096, v4
  global_load_lds_dwordx4 v4, s[20:21] offset:0 sc1
  v_add_u32 v20, s59, v1
  s_branch G_xw
F_rt1:
  s_add_u32 s43, s43, 1
  s_cmp_gt_u32 s43, 4000000
  s_cbranch_scc1 F_ok
  s_mov_b64 exec, vcc
  global_load_dwordx4 v[176:179], v206, s[20:21] sc1
  global_load_dwordx4 v[180:183], v207, s[20:21] sc1
  global_load_dwordx4 v[184:187], v208, s[20:21] sc1
  global_load_dwordx4 v[188:191], v209, s[20:21] sc1
  s_waitcnt vmcnt(0)
  s_branch F_chk
F_rt2:
  s_add_u32 s43, s43, 1
  s_cmp_gt_u32 s43, 4000000
  s_cbranch_scc1 F_okm
  global_load_dwordx2 v[192:193], v204, s[20:21] sc1
  s_waitcnt vmcnt(0)
  s_branch F_chkm
F_cv1:
  s_waitcnt lgkmcnt(0)
  s_barrier
  ds_read2_b32 v[148:149], v217 offset0:112 offset1:113
  ds_read2_b32 v[150:151], v217 offset0:114 offset1:115
  ds_read_b128 v[116:119], v220 offset:384
  ds_read_b128 v[120:123], v220 offset:896
  ds_read_b128 v[124:127], v220 offset:1408
  ds_read_b128 v[128:131], v220 offset:1920
  ds_read2_b32 v[152:153], v216 offset0:112 offset1:113
  ds_read2_b32 v[154:155], v216 offset0:114 offset1:115
  ds_read_b128 v[132:135], v220 offset:2432
  ds_read_b128 v[136:139], v220 offset:2944
  ds_read_b128 v[140:143], v220 offset:3456
  ds_read_b128 v[144:147], v220 offset:3968
  v_mov_b64 v[44:45], 0
  v_mov_b64 v[46:47], 0
  v_mov_b64 v[48:49], 0
  v_mov_b64 v[50:51], 0
  v_mov_b64 v[52:53], 0
  v_mov_b64 v[54:55], 0
  v_mov_b64 v[56:57], 0
  v_mov_b64 v[58:59], 0
  v_mov_b64 v[60:61], 0
  v_mov_b64 v[62:63], 0
  v_mov_b64 v[64:65], 0
  v_mov_b64 v[66:67], 0
  v_mov_b64 v[68:69], 0
  v_mov_b64 v[70:71], 0
  v_mov_b64 v[72:73], 0
  v_mov_b64 v[74:75], 0
  s_mov_b32 s3, 2
F_cl:
  s_waitcnt lgkmcnt(6)
  v_mfma_f32_16x16x32_bf16 v[44:47], v[148:151], v[116:119], v[44:47]
  ds_read2_b32 v[108:109], v217 offset0:96 offset1:97
  v_mfma_f32_16x16x32_bf16 v[48:51], v[148:151], v[120:123], v[48:51]
  ds_read2_b32 v[110:111], v217 offset0:98 offset1:99
  v_mfma_f32_16x16x32_bf16 v[52:55], v[148:151], v[124:127], v[52:55]
  ds_read_b128 v[76:79], v220 offset:320
  v_mfma_f32_16x16x32_bf16 v[56:59], v[148:151], v[128:131], v[56:59]
  ds_read_b128 v[80:83], v220 offset:832
  s_waitcnt lgkmcnt(4)
  v_mfma_f32_16x16x32_bf16 v[60:63], v[148:151], v[132:135], v[60:63]
  ds_read_b128 v[84:87], v220 offset:1344
  v_mfma_f32_16x16x32_bf16 v[64:67], v[148:151], v[136:139], v[64:67]
  ds_read_b128 v[88:91], v220 offset:1856
  v_mfma_f32_16x16x32_bf16 v[68:71], v[148:151], v[140:143], v[68:71]
  ds_read2_b32 v[112:113], v216 offset0:96 offset1:97
  v_mfma_f32_16x16x32_bf16 v[72:75], v[148:151], v[144:147], v[72:75]
  ds_read2_b32 v[114:115], v216 offset0:98 offset1:99
  v_mfma_f32_16x16x32_bf16 v[48:51], v[152:155], v[116:119], v[48:51]
  ds_read_b128 v[92:95], v220 offset:2368
  v_mfma_f32_16x16x32_bf16 v[52:55], v[152:155], v[120:123], v[52:55]
  ds_read_b128 v[96:99], v220 offset:2880
  v_mfma_f32_16x16x32_bf16 v[56:59], v[152:155], v[124:127], v[56:59]
  ds_read_b128 v[100:103], v220 offset:3392
  v_mfma_f32_16x16x32_bf16 v[60:63], v[152:155], v[128:131], v[60:63]
  ds_read_b128 v[104:107], v220 offset:3904
  v_mfma_f32_16x16x32_bf16 v[64:67], v[152:155], v[132:135], v[64:67]
  v_mfma_f32_16x16x32_bf16 v[68:71], v[152:155], v[136:139], v[68:71]
  v_mfma_f32_16x16x32_bf16 v[72:75], v[152:155], v[140:143], v[72:75]
  s_waitcnt lgkmcnt(6)
  v_mfma_f32_16x16x32_bf16 v[44:47], v[108:111], v[76:79], v[44:47]
  ds_read2_b32 v[148:149], v217 offset0:80 offset1:81
  v_mfma_f32_16x16x32_bf16 v[48:51], v[108:111], v[80:83], v[48:51]
  ds_read2_b32 v[150:151], v217 offset0:82 offset1:83
  v_mfma_f32_16x16x32_bf16 v[52:55], v[108:111], v[84:87], v[52:55]
  ds_read_b128 v[116:119], v220 offset:256
  v_mfma_f32_16x16x32_bf16 v[56:59], v[108:111], v[88:91], v[56:59]
  ds_read_b128 v[120:123], v220 offset:768
  s_waitcnt lgkmcnt(4)
  v_mfma_f32_16x16x32_bf16 v[60:63], v[108:111], v[92:95], v[60:63]
  ds_read_b128 v[124:127], v220 offset:1280
  v_mfma_f32_16x16x32_bf16 v[64:67], v[108:111], v[96:99], v[64:67]
  ds_read_b128 v[128:131], v220 offset:1792
  v_mfma_f32_16x16x32_bf16 v[68:71], v[108:111], v[100:103], v[68:71]
  ds_read2_b32 v[152:153], v216 offset0:80 offset1:81
  v_mfma_f32_16x16x32_bf16 v[72:75], v[108:111], v[104:107], v[72:75]
  ds_read2_b32 v[154:155], v216 offset0:82 offset1:83
  v_mfma_f32_16x16x32_bf16 v[48:51], v[112:115], v[76:79], v[48:51]
  ds_read_b128 v[132:135], v220 offset:2304
  v_mfma_f32_16x16x32_bf16 v[52:55], v[112:115], v[80:83], v[52:55]
  ds_read_b128 v[136:139], v220 offset:2816
  v_mfma_f32_16x16x32_bf16 v[56:59], v[112:115], v[84:87], v[56:59]
  ds_read_b128 v[140:143], v220 offset:3328
  v_mfma_f32_16x16x32_bf16 v[60:63], v[112:115], v[88:91], v[60:63]
  ds_read_b128 v[144:147], v220 offset:3840
  v_mfma_f32_16x16x32_bf16 v[64:67], v[112:115], v[92:95], v[64:67]
  v_subrev_u32 v220, 128, v220
  v_subrev_u32 v216, 128, v216
  v_mfma_f32_16x16x32_bf16 v[68:71], v[112:115], v[96:99], v[68:71]
  v_subrev_u32 v217, 128, v217
  s_sub_u32 s3, s3, 1
  v_mfma_f32_16x16x32_bf16 v[72:75], v[112:115], v[100:103], v[72:75]
  s_cbranch_scc0 F_cl
  s_waitcnt lgkmcnt(4)
  v_mfma_f32_16x16x32_bf16 v[44:47], v[148:151], v[116:119], v[44:47]
  ds_write_b128 v221, v[64:67] offset:6400
  v_lshrrev_b32 v24, 5, v2
  v_bfe_u32 v31, v2, 3, 1
  v_mfma_f32_16x16x32_bf16 v[48:51], v[148:151], v[120:123], v[48:51]
  ds_write_b128 v221, v[68:71] offset:7680
  v_mul_u32_u24 v31, 87360, v31
  v_sub_u32 v31, 162944, v31
  v_mfma_f32_16x16x32_bf16 v[52:55], v[148:151], v[124:127], v[52:55]
  ds_write_b128 v221, v[72:75] offset:8960
  v_lshl_add_u32 v21, v24, 4, v31
  s_mov_b32 s18, 0xf0f00f0f
  v_mfma_f32_16x16x32_bf16 v[56:59], v[148:151], v[128:131], v[56:59]
  ds_write_b128 v221, v[44:47] offset:0
  s_mov_b32 s19, 0xf0f00f0f
  v_mov_b32 v31, 0x30000
  v_cndmask_b32 v21, v31, v21, s[18:19]
  v_mfma_f32_16x16x32_bf16 v[48:51], v[152:155], v[116:119], v[48:51]
  s_and_b32 s3, s35, 1
  s_lshl2_add_u32 s3, s3, 125920
  v_mov_b32 v27, s3
  v_mfma_f32_16x16x32_bf16 v[52:55], v[152:155], v[120:123], v[52:55]
  s_lshl2_add_u32 s3, s35, 162944
  v_mov_b32 v26, s3
  v_mfma_f32_16x16x32_bf16 v[56:59], v[152:155], v[124:127], v[56:59]
  ds_write_b128 v221, v[48:51] offset:1280
  v_mfma_f32_16x16x32_bf16 v[60:63], v[152:155], v[128:131], v[60:63]
  ds_write_b128 v221, v[52:55] offset:2560
  s_nop 2
  ds_write_b128 v221, v[56:59] offset:3840
  s_nop 2
  ds_write_b128 v221, v[60:63] offset:5120
  s_waitcnt vmcnt(0)
  s_branch F_b4
G_xs:
  s_add_u32 s43, s43, 1
  s_cmp_gt_u32 s43, 4000000
  s_cbranch_scc1 G_go
  s_waitcnt vmcnt(0)
  ds_read_b64 v[88:89], v14 offset:8192
  ds_read_b64 v[90:91], v14 offset:12288
  ds_read_b64 v[40:41], v14 offset:16384
  ds_read_b64 v[42:43], v14 offset:20480
  ds_read_b64 v[22:23], v14 offset:24576
  s_waitcnt lgkmcnt(0)
  v_max3_u32 v85, v85, v87, v89
  v_max3_u32 v85, v85, v91, v41
  v_max3_u32 v85, v85, v43, v23
  v_cmp_le_u32 vcc, 0xffff0000, v85
  s_nop 0
  s_mov_b64 exec, vcc
  v_add_u32 v4, s27, v15
  s_add_u32 m0, s26, 0
  s_nop 0
  global_load_lds_dwordx4 v4, s[20:21] offset:0 sc1
  s_add_u32 m0, s26, 2048
  s_nop 0
  global_load_lds_dwordx4 v4, s[20:21] offset:2048 sc1
  s_add_u32 m0, s26, 8192
  v_add_u32 v4, 4096, v4
  global_load_lds_dwordx4 v4, s[20:21] offset:0 sc1
  s_add_u32 m0, s26, 10240
  s_nop 0
  global_load_lds_dwordx4 v4, s[20:21] offset:2048 sc1
  s_add_u32 m0, s26, 16384
  v_add_u32 v4, 4096, v4
  global_load_lds_dwordx4 v4, s[20:21] offset:0 sc1
  s_add_u32 m0, s26, 18432
  s_nop 0
  global_load_lds_dwordx4 v4, s[20:21] offset:2048 sc1
  s_add_u32 m0, s26, 24576
  v_add_u32 v4, 4096, v4
  global_load_lds_dwordx4 v4, s[20:21] offset:0 sc1
  s_mov_b64 exec, -1
  s_branch G_xw
G_br:
  s_add_u32 s43, s43, 1
  s_cmp_gt_u32 s43, 4000000
  s_cbranch_scc1 G_bo
  v_add_u32 v4, s27, v15
  s_mov_b64 exec, vcc
  s_add_u32 m0, s26, 8192
  v_add_u32 v4, 4096, v4
  global_load_lds_dwordx4 v4, s[20:21] offset:0 sc1
  s_add_u32 m0, s26, 10240
  s_nop 0
  global_load_lds_dwordx4 v4, s[20:21] offset:2048 sc1
  s_add_u32 m0, s26, 16384
  v_add_u32 v4, 4096, v4
  global_load_lds_dwordx4 v4, s[20:21] offset:0 sc1
  s_add_u32 m0, s26, 18432
  s_nop 0
  global_load_lds_dwordx4 v4, s[20:21] offset:2048 sc1
  s_add_u32 m0, s26, 24576
  v_add_u32 v4, 4096, v4
  global_load_lds_dwordx4 v4, s[20:21] offset:0 sc1
  s_mov_b64 exec, -1
  s_waitcnt vmcnt(0)
  ds_read_b64 v[84:85], v14 offset:8192
  ds_read_b64 v[86:87], v14 offset:12288
  ds_read_b64 v[88:89], v14 offset:16384
  ds_read_b64 v[90:91], v14 offset:20480
  ds_read_b64 v[40:41], v14 offset:24576
  s_waitcnt lgkmcnt(0)
  v_max3_u32 v85, v85, v87, v89
  v_max3_u32 v85, v85, v91, v41
  v_cmp_le_u32 vcc, 0xffff0000, v85
  s_cbranch_vccnz G_br
  s_branch G_bo
G_cr:
  s_add_u32 s43, s43, 1
  s_cmp_gt_u32 s43, 4000000
  s_cbranch_scc1 G_co
  s_mov_b64 exec, vcc
  s_add_u32 m0, s28, 0
  s_nop 0
  global_load_lds_dwordx4 v15, s[20:21] offset:0 sc1
  s_add_u32 m0, s28, 512
  s_nop 0
  global_load_lds_dwordx4 v15, s[20:21] offset:512 sc1
  s_add_u32 m0, s28, 1024
  s_nop 0
  global_load_lds_dwordx4 v15, s[20:21] offset:1024 sc1
  s_add_u32 m0, s28, 1536
  s_nop 0
  global_load_lds_dwordx4 v15, s[20:21] offset:1536 sc1
  s_add_u32 m0, s28, 2048
  s_nop 0
  global_load_lds_dwordx4 v15, s[20:21] offset:2048 sc1
  s_add_u32 m0, s28, 2560
  s_nop 0
  global_load_lds_dwordx4 v15, s[20:21] offset:2560 sc1
  s_add_u32 m0, s28, 3072
  s_nop 0
  global_load_lds_dwordx4 v15, s[20:21] offset:3072 sc1
  s_mov_b64 exec, -1
  s_waitcnt vmcnt(0)
  ds_read_b64 v[84:85], v14 offset:0
  ds_read_b64 v[86:87], v14 offset:1024
  ds_read_b64 v[88:89], v14 offset:2048
  ds_read_b64 v[90:91], v14 offset:3072
  ds_read_b64 v[40:41], v14 offset:4096
  ds_read_b64 v[42:43], v14 offset:5120
  ds_read_b64 v[22:23], v14 offset:6144
  s_waitcnt lgkmcnt(0)
  v_max3_u32 v85, v85, v87, v89
  v_max3_u32 v85, v85, v91, v41
  v_max3_u32 v85, v85, v43, v23
  v_cmp_le_u32 vcc, 0xffff0000, v85
  s_cbranch_vccnz G_cr
  s_branch G_co
G_sr0:
  s_add_u32 s43, s43, 1
  s_cmp_gt_u32 s43, 4000000
  s_cbranch_scc1 G_so0
  global_load_dwordx2 v[44:45], v4, s[22:23] offset:0 sc1
  global_load_dwordx2 v[48:49], v11, s[22:23] offset:0 sc1
  s_waitcnt vmcnt(0)
  v_xor_b32 v20, s40, v45
  v_xor_b32 v21, s40, v49
  v_or_b32 v20, v20, v21
  v_cmp_ne_u32 vcc, 0, v20
  s_cbranch_vccnz G_sr0
  s_branch G_so0
G_sr1:
  s_add_u32 s43, s43, 1
  s_cmp_gt_u32 s43, 4000000
  s_cbranch_scc1 G_so1
  global_load_dwordx2 v[44:45], v4, s[22:23] offset:1024 sc1
  global_load_dwordx2 v[48:49], v11, s[22:23] offset:1024 sc1
  s_waitcnt vmcnt(0)
  v_xor_b32 v20, s40, v45
  v_xor_b32 v21, s40, v49
  v_or_b32 v20, v20, v21
  v_cmp_ne_u32 vcc, 0, v20
  s_cbranch_vccnz G_sr1
  s_branch G_so1
K3_pr0:
  s_add_u32 s43, s43, 1
  s_cmp_gt_u32 s43, 4000000
  s_cbranch_scc1 K3_po0
  global_load_dword v15, v17, s[12:13] sc1
  s_waitcnt vmcnt(0)
  s_branch K3_pc0
G_gr:
  s_add_u32 s43, s43, 1
  s_cmp_gt_u32 s43, 4000000
  s_cbranch_scc1 G_gok
  global_load_dwordx4 v[20:23], v4, s[16:17] sc1
  global_load_dwordx4 v[12:15], v4, s[16:17] offset:16 sc1
  s_waitcnt vmcnt(0)
  v_xor_b32 v21, s40, v21
  v_xor_b32 v23, s40, v23
  v_xor_b32 v13, s40, v13
  v_xor_b32 v15, s40, v15
  v_or3_b32 v21, v21, v23, v13
  v_or_b32 v21, v21, v15
  v_cmp_ne_u32 vcc, 0, v21
  s_cbranch_vccnz G_gr
  s_branch G_gok
K_r014:
  s_add_u32 s43, s43, 1
  s_cmp_gt_u32 s43, 4000000
  s_cbranch_scc1 K_o014
  s_sleep 1
  global_load_dword v2, v17, s[12:13] offset:128 sc1
  s_waitcnt vmcnt(0)
  v_cmp_ne_u32 vcc, s40, v2
  s_cbranch_vccnz K_r014
  global_load_dwordx4 v[40:43], v5, s[8:9] offset:-4096 sc1
  global_load_dwordx4 v[192:195], v5, s[8:9] offset:-3072 sc1
  global_load_dwordx4 v[44:47], v5, s[8:9] offset:-2048 sc1
  global_load_dwordx4 v[48:51], v5, s[8:9] offset:-1024 sc1
  global_load_dwordx4 v[52:55], v5, s[8:9] offset:0 sc1
  global_load_dwordx4 v[56:59], v5, s[8:9] offset:1024 sc1
  global_load_dwordx4 v[60:63], v5, s[8:9] offset:2048 sc1
  global_load_dwordx4 v[64:67], v5, s[8:9] offset:3072 sc1
  global_load_dwordx4 v[68:71], v5, s[10:11] offset:-4096 sc1
  global_load_dwordx4 v[72:75], v5, s[10:11] offset:-3072 sc1
  global_load_dwordx4 v[76:79], v5, s[10:11] offset:-2048 sc1
  global_load_dwordx4 v[80:83], v5, s[10:11] offset:-1024 sc1
  global_load_dwordx4 v[168:171], v5, s[10:11] offset:0 sc1
  global_load_dwordx4 v[172:175], v5, s[10:11] offset:1024 sc1
  s_waitcnt vmcnt(0)
  v_cmp_eq_u32 vcc, -1, v41
  s_cbranch_vccnz K_r014
  s_branch K_o014
K_r015:
  s_add_u32 s43, s43, 1
  s_cmp_gt_u32 s43, 4000000
  s_cbranch_scc1 K_o015
  s_sleep 1
  global_load_dword v2, v17, s[12:13] offset:128 sc1
  s_waitcnt vmcnt(0)
  v_cmp_ne_u32 vcc, s40, v2
  s_cbranch_vccnz K_r015
  global_load_dwordx4 v[192:195], v5, s[8:9] offset:-3072 sc1
  global_load_dwordx4 v[44:47], v5, s[8:9] offset:-2048 sc1
  global_load_dwordx4 v[48:51], v5, s[8:9] offset:-1024 sc1
  global_load_dwordx4 v[52:55], v5, s[8:9] offset:0 sc1
  global_load_dwordx4 v[56:59], v5, s[8:9] offset:1024 sc1
  global_load_dwordx4 v[60:63], v5, s[8:9] offset:2048 sc1
  global_load_dwordx4 v[64:67], v5, s[8:9] offset:3072 sc1
  global_load_dwordx4 v[68:71], v5, s[10:11] offset:-4096 sc1
  global_load_dwordx4 v[72:75], v5, s[10:11] offset:-3072 sc1
  global_load_dwordx4 v[76:79], v5, s[10:11] offset:-2048 sc1
  global_load_dwordx4 v[80:83], v5, s[10:11] offset:-1024 sc1
  global_load_dwordx4 v[168:171], v5, s[10:11] offset:0 sc1
  global_load_dwordx4 v[172:175], v5, s[10:11] offset:1024 sc1
  s_waitcnt vmcnt(0)
  v_cmp_eq_u32 vcc, -1, v193
  s_cbranch_vccnz K_r015
  s_branch K_o015
K_r016:
  s_add_u32 s43, s43, 1
  s_cmp_gt_u32 s43, 4000000
  s_cbranch_scc1 K_o016
  s_sleep 1
  global_load_dword v2, v17, s[12:13] offset:128 sc1
  s_waitcnt vmcnt(0)
  v_cmp_ne_u32 vcc, s40, v2
  s_cbranch_vccnz K_r016
  global_load_dwordx4 v[44:47], v5, s[8:9] offset:-2048 sc1
  global_load_dwordx4 v[48:51], v5, s[8:9] offset:-1024 sc1
  global_load_dwordx4 v[52:55], v5, s[8:9] offset:0 sc1
  global_load_dwordx4 v[56:59], v5, s[8:9] offset:1024 sc1
  global_load_dwordx4 v[60:63], v5, s[8:9] offset:2048 sc1
  global_load_dwordx4 v[64:67], v5, s[8:9] offset:3072 sc1
  global_load_dwordx4 v[68:71], v5, s[10:11] offset:-4096 sc1
  global_load_dwordx4 v[72:75], v5, s[10:11] offset:-3072 sc1
  global_load_dwordx4 v[76:79], v5, s[10:11] offset:-2048 sc1
  global_load_dwordx4 v[80:83], v5, s[10:11] offset:-1024 sc1
  global_load_dwordx4 v[168:171], v5, s[10:11] offset:0 sc1
  global_load_dwordx4 v[172:175], v5, s[10:11] offset:1024 sc1
  s_waitcnt vmcnt(0)
  v_cmp_eq_u32 vcc, -1, v45
  s_cbranch_vccnz K_r016
  s_branch K_o016
K_r017:
  s_add_u32 s43, s43, 1
  s_cmp_gt_u32 s43, 4000000
  s_cbranch_scc1 K_o017
  s_sleep 1
  global_load_dword v2, v17, s[12:13] offset:128 sc1
  s_waitcnt vmcnt(0)
  v_cmp_ne_u32 vcc, s40, v2
  s_cbranch_vccnz K_r017
  global_load_dwordx4 v[48:51], v5, s[8:9] offset:-1024 sc1
  global_load_dwordx4 v[52:55], v5, s[8:9] offset:0 sc1
  global_load_dwordx4 v[56:59], v5, s[8:9] offset:1024 sc1
  global_load_dwordx4 v[60:63], v5, s[8:9] offset:2048 sc1
  global_load_dwordx4 v[64:67], v5, s[8:9] offset:3072 sc1
  global_load_dwordx4 v[68:71], v5, s[10:11] offset:-4096 sc1
  global_load_dwordx4 v[72:75], v5, s[10:11] offset:-3072 sc1
  global_load_dwordx4 v[76:79], v5, s[10:11] offset:-2048 sc1
  global_load_dwordx4 v[80:83], v5, s[10:11] offset:-1024 sc1
  global_load_dwordx4 v[168:171], v5, s[10:11] offset:0 sc1
  global_load_dwordx4 v[172:175], v5, s[10:11] offset:1024 sc1
  s_waitcnt vmcnt(0)
  v_cmp_eq_u32 vcc, -1, v49
  s_cbranch_vccnz K_r017
  s_branch K_o017
K_r018:
  s_add_u32 s43, s43, 1
  s_cmp_gt_u32 s43, 4000000
  s_cbranch_scc1 K_o018
  s_sleep 1
  global_load_dword v2, v17, s[12:13] offset:128 sc1
  s_waitcnt vmcnt(0)
  v_cmp_ne_u32 vcc, s40, v2
  s_cbranch_vccnz K_r018
  global_load_dwordx4 v[52:55], v5, s[8:9] offset:0 sc1
  global_load_dwordx4 v[56:59], v5, s[8:9] offset:1024 sc1
  global_load_dwordx4 v[60:63], v5, s[8:9] offset:2048 sc1
  global_load_dwordx4 v[64:67], v5, s[8:9] offset:3072 sc1
  global_load_dwordx4 v[68:71], v5, s[10:11] offset:-4096 sc1
  global_load_dwordx4 v[72:75], v5, s[10:11] offset:-3072 sc1
  global_load_dwordx4 v[76:79], v5, s[10:11] offset:-2048 sc1
  global_load_dwordx4 v[80:83], v5, s[10:11] offset:-1024 sc1
  global_load_dwordx4 v[168:171], v5, s[10:11] offset:0 sc1
  global_load_dwordx4 v[172:175], v5, s[10:11] offset:1024 sc1
  s_waitcnt vmcnt(0)
  v_cmp_eq_u32 vcc, -1, v53
  s_cbranch_vccnz K_r018
  s_branch K_o018
K_r019:
  s_add_u32 s43, s43, 1
  s_cmp_gt_u32 s43, 4000000
  s_cbranch_scc1 K_o019
  s_sleep 1
  global_load_dword v2, v17, s[12:13] offset:128 sc1
  s_waitcnt vmcnt(0)
  v_cmp_ne_u32 vcc, s40, v2
  s_cbranch_vccnz K_r019
  global_load_dwordx4 v[56:59], v5, s[8:9] offset:1024 sc1
  global_load_dwordx4 v[60:63], v5, s[8:9] offset:2048 sc1
  global_load_dwordx4 v[64:67], v5, s[8:9] offset:3072 sc1
  global_load_dwordx4 v[68:71], v5, s[10:11] offset:-4096 sc1
  global_load_dwordx4 v[72:75], v5, s[10:11] offset:-3072 sc1
  global_load_dwordx4 v[76:79], v5, s[10:11] offset:-2048 sc1
  global_load_dwordx4 v[80:83], v5, s[10:11] offset:-1024 sc1
  global_load_dwordx4 v[168:171], v5, s[10:11] offset:0 sc1
  global_load_dwordx4 v[172:175], v5, s[10:11] offset:1024 sc1
  s_waitcnt vmcnt(0)
  v_cmp_eq_u32 vcc, -1, v57
  s_cbranch_vccnz K_r019
  s_branch K_o019
K_r020:
  s_add_u32 s43, s43, 1
  s_cmp_gt_u32 s43, 4000000
  s_cbranch_scc1 K_o020
  s_sleep 1
  global_load_dword v2, v17, s[12:13] offset:128 sc1
  s_waitcnt vmcnt(0)
  v_cmp_ne_u32 vcc, s40, v2
  s_cbranch_vccnz K_r020
  global_load_dwordx4 v[60:63], v5, s[8:9] offset:2048 sc1
  global_load_dwordx4 v[64:67], v5, s[8:9] offset:3072 sc1
  global_load_dwordx4 v[68:71], v5, s[10:11] offset:-4096 sc1
  global_load_dwordx4 v[72:75], v5, s[10:11] offset:-3072 sc1
  global_load_dwordx4 v[76:79], v5, s[10:11] offset:-2048 sc1
  global_load_dwordx4 v[80:83], v5, s[10:11] offset:-1024 sc1
  global_load_dwordx4 v[168:171], v5, s[10:11] offset:0 sc1
  global_load_dwordx4 v[172:175], v5, s[10:11] offset:1024 sc1
  s_waitcnt vmcnt(0)
  v_cmp_eq_u32 vcc, -1, v61
  s_cbranch_vccnz K_r020
  s_branch K_o020
K_r021:
  s_add_u32 s43, s43, 1
  s_cmp_gt_u32 s43, 4000000
  s_cbranch_scc1 K_o021
  s_sleep 1
  global_load_dword v2, v17, s[12:13] offset:128 sc1
  s_waitcnt vmcnt(0)
  v_cmp_ne_u32 vcc, s40, v2
  s_cbranch_vccnz K_r021
  global_load_dwordx4 v[64:67], v5, s[8:9] offset:3072 sc1
  global_load_dwordx4 v[68:71], v5, s[10:11] offset:-4096 sc1
  global_load_dwordx4 v[72:75], v5, s[10:11] offset:-3072 sc1
  global_load_dwordx4 v[76:79], v5, s[10:11] offset:-2048 sc1
  global_load_dwordx4 v[80:83], v5, s[10:11] offset:-1024 sc1
  global_load_dwordx4 v[168:171], v5, s[10:11] offset:0 sc1
  global_load_dwordx4 v[172:175], v5, s[10:11] offset:1024 sc1
  s_waitcnt vmcnt(0)
  v_cmp_eq_u32 vcc, -1, v65
  s_cbranch_vccnz K_r021
  s_branch K_o021
K_r022:
  s_add_u32 s43, s43, 1
  s_cmp_gt_u32 s43, 4000000
  s_cbranch_scc1 K_o022
  s_sleep 1
  global_load_dword v2, v17, s[12:13] offset:128 sc1
  s_waitcnt vmcnt(0)
  v_cmp_ne_u32 vcc, s40, v2
  s_cbranch_vccnz K_r022
  global_load_dwordx4 v[68:71], v5, s[10:11] offset:-4096 sc1
  global_load_dwordx4 v[72:75], v5, s[10:11] offset:-3072 sc1
  global_load_dwordx4 v[76:79], v5, s[10:11] offset:-2048 sc1
  global_load_dwordx4 v[80:83], v5, s[10:11] offset:-1024 sc1
  global_load_dwordx4 v[168:171], v5, s[10:11] offset:0 sc1
  global_load_dwordx4 v[172:175], v5, s[10:11] offset:1024 sc1
  s_waitcnt vmcnt(0)
  v_cmp_eq_u32 vcc, -1, v69
  s_cbranch_vccnz K_r022
  s_branch K_o022
K_r023:
  s_add_u32 s43, s43, 1
  s_cmp_gt_u32 s43, 4000000
  s_cbranch_scc1 K_o023
  s_sleep 1
  global_load_dword v2, v17, s[12:13] offset:128 sc1
  s_waitcnt vmcnt(0)
  v_cmp_ne_u32 vcc, s40, v2
  s_cbranch_vccnz K_r023
  global_load_dwordx4 v[72:75], v5, s[10:11] offset:-3072 sc1
  global_load_dwordx4 v[76:79], v5, s[10:11] offset:-2048 sc1
  global_load_dwordx4 v[80:83], v5, s[10:11] offset:-1024 sc1
  global_load_dwordx4 v[168:171], v5, s[10:11] offset:0 sc1
  global_load_dwordx4 v[172:175], v5, s[10:11] offset:1024 sc1
  s_waitcnt vmcnt(0)
  v_cmp_eq_u32 vcc, -1, v73
  s_cbranch_vccnz K_r023
  s_branch K_o023
K_r024:
  s_add_u32 s43, s43, 1
  s_cmp_gt_u32 s43, 4000000
  s_cbranch_scc1 K_o024
  s_sleep 1
  global_load_dword v2, v17, s[12:13] offset:128 sc1
  s_waitcnt vmcnt(0)
  v_cmp_ne_u32 vcc, s40, v2
  s_cbranch_vccnz K_r024
  global_load_dwordx4 v[76:79], v5, s[10:11] offset:-2048 sc1
  global_load_dwordx4 v[80:83], v5, s[10:11] offset:-1024 sc1
  global_load_dwordx4 v[168:171], v5, s[10:11] offset:0 sc1
  global_load_dwordx4 v[172:175], v5, s[10:11] offset:1024 sc1
  s_waitcnt vmcnt(0)
  v_cmp_eq_u32 vcc, -1, v77
  s_cbranch_vccnz K_r024
  s_branch K_o024
K_r025:
  s_add_u32 s43, s43, 1
  s_cmp_gt_u32 s43, 4000000
  s_cbranch_scc1 K_o025
  s_sleep 1
  global_load_dword v2, v17, s[12:13] offset:128 sc1
  s_waitcnt vmcnt(0)
  v_cmp_ne_u32 vcc, s40, v2
  s_cbranch_vccnz K_r025
  global_load_dwordx4 v[80:83], v5, s[10:11] offset:-1024 sc1
  global_load_dwordx4 v[168:171], v5, s[10:11] offset:0 sc1
  global_load_dwordx4 v[172:175], v5, s[10:11] offset:1024 sc1
  s_waitcnt vmcnt(0)
  v_cmp_eq_u32 vcc, -1, v81
  s_cbranch_vccnz K_r025
  s_branch K_o025
K_r026:
  s_add_u32 s43, s43, 1
  s_cmp_gt_u32 s43, 4000000
  s_cbranch_scc1 K_o026
  s_sleep 1
  global_load_dword v2, v17, s[12:13] offset:128 sc1
  s_waitcnt vmcnt(0)
  v_cmp_ne_u32 vcc, s40, v2
  s_cbranch_vccnz K_r026
  global_load_dwordx4 v[168:171], v5, s[10:11] offset:0 sc1
  global_load_dwordx4 v[172:175], v5, s[10:11] offset:1024 sc1
  s_waitcnt vmcnt(0)
  v_cmp_eq_u32 vcc, -1, v169
  s_cbranch_vccnz K_r026
  s_branch K_o026
K_r027:
  s_add_u32 s43, s43, 1
  s_cmp_gt_u32 s43, 4000000
  s_cbranch_scc1 K_o027
  s_sleep 1
  global_load_dword v2, v17, s[12:13] offset:128 sc1
  s_waitcnt vmcnt(0)
  v_cmp_ne_u32 vcc, s40, v2
  s_cbranch_vccnz K_r027
  global_load_dwordx4 v[172:175], v5, s[10:11] offset:1024 sc1
  s_waitcnt vmcnt(0)
  v_cmp_eq_u32 vcc, -1, v173
  s_cbranch_vccnz K_r027
  s_branch K_o027
K3_pr1:
  s_add_u32 s43, s43, 1
  s_cmp_gt_u32 s43, 4000000
  s_cbranch_scc1 K3_po1
  global_load_dword v15, v17, s[12:13] sc1
  s_waitcnt vmcnt(0)
  s_branch K3_pc1
K_r114:
  s_add_u32 s43, s43, 1
  s_cmp_gt_u32 s43, 4000000
  s_cbranch_scc1 K_o114
  s_sleep 1
  global_load_dword v2, v17, s[12:13] offset:128 sc1
  s_waitcnt vmcnt(0)
  v_cmp_ne_u32 vcc, s40, v2
  s_cbranch_vccnz K_r114
  global_load_dwordx4 v[40:43], v5, s[8:9] offset:-4096 sc1
  global_load_dwordx4 v[192:195], v5, s[8:9] offset:-3072 sc1
  global_load_dwordx4 v[44:47], v5, s[8:9] offset:-2048 sc1
  global_load_dwordx4 v[48:51], v5, s[8:9] offset:-1024 sc1
  global_load_dwordx4 v[52:55], v5, s[8:9] offset:0 sc1
  global_load_dwordx4 v[56:59], v5, s[8:9] offset:1024 sc1
  global_load_dwordx4 v[60:63], v5, s[8:9] offset:2048 sc1
  global_load_dwordx4 v[64:67], v5, s[8:9] offset:3072 sc1
  global_load_dwordx4 v[68:71], v5, s[10:11] offset:-4096 sc1
  global_load_dwordx4 v[72:75], v5, s[10:11] offset:-3072 sc1
  global_load_dwordx4 v[76:79], v5, s[10:11] offset:-2048 sc1
  global_load_dwordx4 v[80:83], v5, s[10:11] offset:-1024 sc1
  global_load_dwordx4 v[168:171], v5, s[10:11] offset:0 sc1
  global_load_dwordx4 v[172:175], v5, s[10:11] offset:1024 sc1
  s_waitcnt vmcnt(0)
  v_cmp_eq_u32 vcc, -1, v41
  s_cbranch_vccnz K_r114
  s_branch K_o114
K_r115:
  s_add_u32 s43, s43, 1
  s_cmp_gt_u32 s43, 4000000
  s_cbranch_scc1 K_o115
  s_sleep 1
  global_load_dword v2, v17, s[12:13] offset:128 sc1
  s_waitcnt vmcnt(0)
  v_cmp_ne_u32 vcc, s40, v2
  s_cbranch_vccnz K_r115
  global_load_dwordx4 v[192:195], v5, s[8:9] offset:-3072 sc1
  global_load_dwordx4 v[44:47], v5, s[8:9] offset:-2048 sc1
  global_load_dwordx4 v[48:51], v5, s[8:9] offset:-1024 sc1
  global_load_dwordx4 v[52:55], v5, s[8:9] offset:0 sc1
  global_load_dwordx4 v[56:59], v5, s[8:9] offset:1024 sc1
  global_load_dwordx4 v[60:63], v5, s[8:9] offset:2048 sc1
  global_load_dwordx4 v[64:67], v5, s[8:9] offset:3072 sc1
  global_load_dwordx4 v[68:71], v5, s[10:11] offset:-4096 sc1
  global_load_dwordx4 v[72:75], v5, s[10:11] offset:-3072 sc1
  global_load_dwordx4 v[76:79], v5, s[10:11] offset:-2048 sc1
  global_load_dwordx4 v[80:83], v5, s[10:11] offset:-1024 sc1
  global_load_dwordx4 v[168:171], v5, s[10:11] offset:0 sc1
  global_load_dwordx4 v[172:175], v5, s[10:11] offset:1024 sc1
  s_waitcnt vmcnt(0)
  v_cmp_eq_u32 vcc, -1, v193
  s_cbranch_vccnz K_r115
  s_branch K_o115
K_r116:
  s_add_u32 s43, s43, 1
  s_cmp_gt_u32 s43, 4000000
  s_cbranch_scc1 K_o116
  s_sleep 1
  global_load_dword v2, v17, s[12:13] offset:128 sc1
  s_waitcnt vmcnt(0)
  v_cmp_ne_u32 vcc, s40, v2
  s_cbranch_vccnz K_r116
  global_load_dwordx4 v[44:47], v5, s[8:9] offset:-2048 sc1
  global_load_dwordx4 v[48:51], v5, s[8:9] offset:-1024 sc1
  global_load_dwordx4 v[52:55], v5, s[8:9] offset:0 sc1
  global_load_dwordx4 v[56:59], v5, s[8:9] offset:1024 sc1
  global_load_dwordx4 v[60:63], v5, s[8:9] offset:2048 sc1
  global_load_dwordx4 v[64:67], v5, s[8:9] offset:3072 sc1
  global_load_dwordx4 v[68:71], v5, s[10:11] offset:-4096 sc1
  global_load_dwordx4 v[72:75], v5, s[10:11] offset:-3072 sc1
  global_load_dwordx4 v[76:79], v5, s[10:11] offset:-2048 sc1
  global_load_dwordx4 v[80:83], v5, s[10:11] offset:-1024 sc1
  global_load_dwordx4 v[168:171], v5, s[10:11] offset:0 sc1
  global_load_dwordx4 v[172:175], v5, s[10:11] offset:1024 sc1
  s_waitcnt vmcnt(0)
  v_cmp_eq_u32 vcc, -1, v45
  s_cbranch_vccnz K_r116
  s_branch K_o116
K_r117:
  s_add_u32 s43, s43, 1
  s_cmp_gt_u32 s43, 4000000
  s_cbranch_scc1 K_o117
  s_sleep 1
  global_load_dword v2, v17, s[12:13] offset:128 sc1
  s_waitcnt vmcnt(0)
  v_cmp_ne_u32 vcc, s40, v2
  s_cbranch_vccnz K_r117
  global_load_dwordx4 v[48:51], v5, s[8:9] offset:-1024 sc1
  global_load_dwordx4 v[52:55], v5, s[8:9] offset:0 sc1
  global_load_dwordx4 v[56:59], v5, s[8:9] offset:1024 sc1
  global_load_dwordx4 v[60:63], v5, s[8:9] offset:2048 sc1
  global_load_dwordx4 v[64:67], v5, s[8:9] offset:3072 sc1
  global_load_dwordx4 v[68:71], v5, s[10:11] offset:-4096 sc1
  global_load_dwordx4 v[72:75], v5, s[10:11] offset:-3072 sc1
  global_load_dwordx4 v[76:79], v5, s[10:11] offset:-2048 sc1
  global_load_dwordx4 v[80:83], v5, s[10:11] offset:-1024 sc1
  global_load_dwordx4 v[168:171], v5, s[10:11] offset:0 sc1
  global_load_dwordx4 v[172:175], v5, s[10:11] offset:1024 sc1
  s_waitcnt vmcnt(0)
  v_cmp_eq_u32 vcc, -1, v49
  s_cbranch_vccnz K_r117
  s_branch K_o117
K_r118:
  s_add_u32 s43, s43, 1
  s_cmp_gt_u32 s43, 4000000
  s_cbranch_scc1 K_o118
  s_sleep 1
  global_load_dword v2, v17, s[12:13] offset:128 sc1
  s_waitcnt vmcnt(0)
  v_cmp_ne_u32 vcc, s40, v2
  s_cbranch_vccnz K_r118
  global_load_dwordx4 v[52:55], v5, s[8:9] offset:0 sc1
  global_load_dwordx4 v[56:59], v5, s[8:9] offset:1024 sc1
  global_load_dwordx4 v[60:63], v5, s[8:9] offset:2048 sc1
  global_load_dwordx4 v[64:67], v5, s[8:9] offset:3072 sc1
  global_load_dwordx4 v[68:71], v5, s[10:11] offset:-4096 sc1
  global_load_dwordx4 v[72:75], v5, s[10:11] offset:-3072 sc1
  global_load_dwordx4 v[76:79], v5, s[10:11] offset:-2048 sc1
  global_load_dwordx4 v[80:83], v5, s[10:11] offset:-1024 sc1
  global_load_dwordx4 v[168:171], v5, s[10:11] offset:0 sc1
  global_load_dwordx4 v[172:175], v5, s[10:11] offset:1024 sc1
  s_waitcnt vmcnt(0)
  v_cmp_eq_u32 vcc, -1, v53
  s_cbranch_vccnz K_r118
  s_branch K_o118
K_r119:
  s_add_u32 s43, s43, 1
  s_cmp_gt_u32 s43, 4000000
  s_cbranch_scc1 K_o119
  s_sleep 1
  global_load_dword v2, v17, s[12:13] offset:128 sc1
  s_waitcnt vmcnt(0)
  v_cmp_ne_u32 vcc, s40, v2
  s_cbranch_vccnz K_r119
  global_load_dwordx4 v[56:59], v5, s[8:9] offset:1024 sc1
  global_load_dwordx4 v[60:63], v5, s[8:9] offset:2048 sc1
  global_load_dwordx4 v[64:67], v5, s[8:9] offset:3072 sc1
  global_load_dwordx4 v[68:71], v5, s[10:11] offset:-4096 sc1
  global_load_dwordx4 v[72:75], v5, s[10:11] offset:-3072 sc1
  global_load_dwordx4 v[76:79], v5, s[10:11] offset:-2048 sc1
  global_load_dwordx4 v[80:83], v5, s[10:11] offset:-1024 sc1
  global_load_dwordx4 v[168:171], v5, s[10:11] offset:0 sc1
  global_load_dwordx4 v[172:175], v5, s[10:11] offset:1024 sc1
  s_waitcnt vmcnt(0)
  v_cmp_eq_u32 vcc, -1, v57
  s_cbranch_vccnz K_r119
  s_branch K_o119
K_r120:
  s_add_u32 s43, s43, 1
  s_cmp_gt_u32 s43, 4000000
  s_cbranch_scc1 K_o120
  s_sleep 1
  global_load_dword v2, v17, s[12:13] offset:128 sc1
  s_waitcnt vmcnt(0)
  v_cmp_ne_u32 vcc, s40, v2
  s_cbranch_vccnz K_r120
  global_load_dwordx4 v[60:63], v5, s[8:9] offset:2048 sc1
  global_load_dwordx4 v[64:67], v5, s[8:9] offset:3072 sc1
  global_load_dwordx4 v[68:71], v5, s[10:11] offset:-4096 sc1
  global_load_dwordx4 v[72:75], v5, s[10:11] offset:-3072 sc1
  global_load_dwordx4 v[76:79], v5, s[10:11] offset:-2048 sc1
  global_load_dwordx4 v[80:83], v5, s[10:11] offset:-1024 sc1
  global_load_dwordx4 v[168:171], v5, s[10:11] offset:0 sc1
  global_load_dwordx4 v[172:175], v5, s[10:11] offset:1024 sc1
  s_waitcnt vmcnt(0)
  v_cmp_eq_u32 vcc, -1, v61
  s_cbranch_vccnz K_r120
  s_branch K_o120
K_r121:
  s_add_u32 s43, s43, 1
  s_cmp_gt_u32 s43, 4000000
  s_cbranch_scc1 K_o121
  s_sleep 1
  global_load_dword v2, v17, s[12:13] offset:128 sc1
  s_waitcnt vmcnt(0)
  v_cmp_ne_u32 vcc, s40, v2
  s_cbranch_vccnz K_r121
  global_load_dwordx4 v[64:67], v5, s[8:9] offset:3072 sc1
  global_load_dwordx4 v[68:71], v5, s[10:11] offset:-4096 sc1
  global_load_dwordx4 v[72:75], v5, s[10:11] offset:-3072 sc1
  global_load_dwordx4 v[76:79], v5, s[10:11] offset:-2048 sc1
  global_load_dwordx4 v[80:83], v5, s[10:11] offset:-1024 sc1
  global_load_dwordx4 v[168:171], v5, s[10:11] offset:0 sc1
  global_load_dwordx4 v[172:175], v5, s[10:11] offset:1024 sc1
  s_waitcnt vmcnt(0)
  v_cmp_eq_u32 vcc, -1, v65
  s_cbranch_vccnz K_r121
  s_branch K_o121
K_r122:
  s_add_u32 s43, s43, 1
  s_cmp_gt_u32 s43, 4000000
  s_cbranch_scc1 K_o122
  s_sleep 1
  global_load_dword v2, v17, s[12:13] offset:128 sc1
  s_waitcnt vmcnt(0)
  v_cmp_ne_u32 vcc, s40, v2
  s_cbranch_vccnz K_r122
  global_load_dwordx4 v[68:71], v5, s[10:11] offset:-4096 sc1
  global_load_dwordx4 v[72:75], v5, s[10:11] offset:-3072 sc1
  global_load_dwordx4 v[76:79], v5, s[10:11] offset:-2048 sc1
  global_load_dwordx4 v[80:83], v5, s[10:11] offset:-1024 sc1
  global_load_dwordx4 v[168:171], v5, s[10:11] offset:0 sc1
  global_load_dwordx4 v[172:175], v5, s[10:11] offset:1024 sc1
  s_waitcnt vmcnt(0)
  v_cmp_eq_u32 vcc, -1, v69
  s_cbranch_vccnz K_r122
  s_branch K_o122
K_r123:
  s_add_u32 s43, s43, 1
  s_cmp_gt_u32 s43, 4000000
  s_cbranch_scc1 K_o123
  s_sleep 1
  global_load_dword v2, v17, s[12:13] offset:128 sc1
  s_waitcnt vmcnt(0)
  v_cmp_ne_u32 vcc, s40, v2
  s_cbranch_vccnz K_r123
  global_load_dwordx4 v[72:75], v5, s[10:11] offset:-3072 sc1
  global_load_dwordx4 v[76:79], v5, s[10:11] offset:-2048 sc1
  global_load_dwordx4 v[80:83], v5, s[10:11] offset:-1024 sc1
  global_load_dwordx4 v[168:171], v5, s[10:11] offset:0 sc1
  global_load_dwordx4 v[172:175], v5, s[10:11] offset:1024 sc1
  s_waitcnt vmcnt(0)
  v_cmp_eq_u32 vcc, -1, v73
  s_cbranch_vccnz K_r123
  s_branch K_o123
K_r124:
  s_add_u32 s43, s43, 1
  s_cmp_gt_u32 s43, 4000000
  s_cbranch_scc1 K_o124
  s_sleep 1
  global_load_dword v2, v17, s[12:13] offset:128 sc1
  s_waitcnt vmcnt(0)
  v_cmp_ne_u32 vcc, s40, v2
  s_cbranch_vccnz K_r124
  global_load_dwordx4 v[76:79], v5, s[10:11] offset:-2048 sc1
  global_load_dwordx4 v[80:83], v5, s[10:11] offset:-1024 sc1
  global_load_dwordx4 v[168:171], v5, s[10:11] offset:0 sc1
  global_load_dwordx4 v[172:175], v5, s[10:11] offset:1024 sc1
  s_waitcnt vmcnt(0)
  v_cmp_eq_u32 vcc, -1, v77
  s_cbranch_vccnz K_r124
  s_branch K_o124
K_r125:
  s_add_u32 s43, s43, 1
  s_cmp_gt_u32 s43, 4000000
  s_cbranch_scc1 K_o125
  s_sleep 1
  global_load_dword v2, v17, s[12:13] offset:128 sc1
  s_waitcnt vmcnt(0)
  v_cmp_ne_u32 vcc, s40, v2
  s_cbranch_vccnz K_r125
  global_load_dwordx4 v[80:83], v5, s[10:11] offset:-1024 sc1
  global_load_dwordx4 v[168:171], v5, s[10:11] offset:0 sc1
  global_load_dwordx4 v[172:175], v5, s[10:11] offset:1024 sc1
  s_waitcnt vmcnt(0)
  v_cmp_eq_u32 vcc, -1, v81
  s_cbranch_vccnz K_r125
  s_branch K_o125
K_r126:
  s_add_u32 s43, s43, 1
  s_cmp_gt_u32 s43, 4000000
  s_cbranch_scc1 K_o126
  s_sleep 1
  global_load_dword v2, v17, s[12:13] offset:128 sc1
  s_waitcnt vmcnt(0)
  v_cmp_ne_u32 vcc, s40, v2
  s_cbranch_vccnz K_r126
  global_load_dwordx4 v[168:171], v5, s[10:11] offset:0 sc1
  global_load_dwordx4 v[172:175], v5, s[10:11] offset:1024 sc1
  s_waitcnt vmcnt(0)
  v_cmp_eq_u32 vcc, -1, v169
  s_cbranch_vccnz K_r126
  s_branch K_o126
K_r127:
  s_add_u32 s43, s43, 1
  s_cmp_gt_u32 s43, 4000000
  s_cbranch_scc1 K_o127
  s_sleep 1
  global_load_dword v2, v17, s[12:13] offset:128 sc1
  s_waitcnt vmcnt(0)
  v_cmp_ne_u32 vcc, s40, v2
  s_cbranch_vccnz K_r127
  global_load_dwordx4 v[172:175], v5, s[10:11] offset:1024 sc1
  s_waitcnt vmcnt(0)
  v_cmp_eq_u32 vcc, -1, v173
  s_cbranch_vccnz K_r127
  s_branch K_o127
F_rt4:
  s_add_u32 s43, s43, 1
  s_cmp_gt_u32 s43, 4000000
  s_cbranch_scc1 F_ok2
  global_load_dwordx4 v[40:43], v220, s[20:21] sc1
  s_waitcnt vmcnt(0)
  s_branch F_chk2
F_ep:
  s_lshl_b32 s3, s2, 7
  s_add_u32 s3, s3, 65536
  v_mov_b32 v9, s3
  v_mov_b32 v10, 256
  v_mov_b32 v11, s40
  s_mov_b64 exec, 1
  global_store_dword v9, v11, s[20:21] sc1
  s_cmp_lg_u32 s2, 0
  s_cbranch_scc1 F_ep2
  global_store_dword v10, v11, s[20:21]
F_ep2:
  s_mov_b64 exec, -1
  s_branch F_ep1
G_fr:
  s_cmp_lg_u32 s33, 4
  s_cbranch_scc1 G_sg1
  s_add_u32 s43, s43, 1
  s_cmp_gt_u32 s43, 4000000
  s_cbranch_scc1 G_fo
  global_load_dword v23, v22, s[20:21] sc1
  s_waitcnt vmcnt(0)
  s_branch G_fc
G_sg:
  s_lshl1_add_u32 s3, s66, s69
  s_lshl_b32 s3, s3, 7
  s_add_u32 s3, s3, 1933312
  v_mov_b32 v10, s3
  v_mov_b32 v11, s40
  s_mov_b64 exec, 1
  global_store_dword v10, v11, s[20:21] sc1
  s_mov_b64 exec, -1
  s_branch G_sg1
F_spare:
  s_waitcnt vmcnt(6)
  v_lshlrev_b32 v44, 16, v10
  v_and_b32 v45, 0xffff0000, v10
  v_lshlrev_b32 v46, 16, v11
  v_and_b32 v47, 0xffff0000, v11
  v_mul_f32 v48, s27, v44
  v_mul_f32 v49, s27, v45
  v_mul_f32 v50, s27, v46
  v_mul_f32 v51, s27, v47
  v_exp_f32 v48, v48
  v_exp_f32 v49, v49
  v_exp_f32 v50, v50
  v_exp_f32 v51, v51
  v_add_f32 v48, 1.0, v48
  v_add_f32 v49, 1.0, v49
  v_add_f32 v50, 1.0, v50
  v_add_f32 v51, 1.0, v51
  v_rcp_f32 v48, v48
  v_rcp_f32 v49, v49
  v_rcp_f32 v50, v50
  v_rcp_f32 v51, v51
  v_mul_f32 v44, v44, v48
  v_mul_f32 v45, v45, v49
  v_mul_f32 v46, v46, v50
  v_mul_f32 v47, v47, v51
  v_cvt_pk_bf16_f32 v48, v44, v45
  v_cvt_pk_bf16_f32 v49, v46, v47
  v_lshlrev_b32 v44, 16, v48
  v_and_b32 v45, 0xffff0000, v48
  v_lshlrev_b32 v46, 16, v49
  v_and_b32 v47, 0xffff0000, v49
  s_waitcnt vmcnt(5)
  v_lshlrev_b32 v56, 16, v96
  v_and_b32 v57, 0xffff0000, v96
  v_lshlrev_b32 v58, 16, v97
  v_and_b32 v59, 0xffff0000, v97
  v_lshlrev_b32 v60, 16, v98
  v_and_b32 v61, 0xffff0000, v98
  v_lshlrev_b32 v62, 16, v99
  v_and_b32 v63, 0xffff0000, v99
  v_mul_f32 v64, v44, v56
  v_mul_f32 v65, v44, v57
  v_mul_f32 v66, v44, v58
  v_mul_f32 v67, v44, v59
  v_mul_f32 v68, v44, v60
  v_mul_f32 v69, v44, v61
  v_mul_f32 v70, v44, v62
  v_mul_f32 v71, v44, v63
  s_waitcnt vmcnt(4)
  v_lshlrev_b32 v56, 16, v100
  v_and_b32 v57, 0xffff0000, v100
  v_lshlrev_b32 v58, 16, v101
  v_and_b32 v59, 0xffff0000, v101
  v_lshlrev_b32 v60, 16, v102
  v_and_b32 v61, 0xffff0000, v102
  v_lshlrev_b32 v62, 16, v103
  v_and_b32 v63, 0xffff0000, v103
  v_fmac_f32 v64, v45, v56
  v_fmac_f32 v65, v45, v57
  v_fmac_f32 v66, v45, v58
  v_fmac_f32 v67, v45, v59
  v_fmac_f32 v68, v45, v60
  v_fmac_f32 v69, v45, v61
  v_fmac_f32 v70, v45, v62
  v_fmac_f32 v71, v45, v63
  s_waitcnt vmcnt(3)
  v_lshlrev_b32 v56, 16, v104
  v_and_b32 v57, 0xffff0000, v104
  v_lshlrev_b32 v58, 16, v105
  v_and_b32 v59, 0xffff0000, v105
  v_lshlrev_b32 v60, 16, v106
  v_and_b32 v61, 0xffff0000, v106
  v_lshlrev_b32 v62, 16, v107
  v_and_b32 v63, 0xffff0000, v107
  v_fmac_f32 v64, v46, v56
  v_fmac_f32 v65, v46, v57
  v_fmac_f32 v66, v46, v58
  v_fmac_f32 v67, v46, v59
  v_fmac_f32 v68, v46, v60
  v_fmac_f32 v69, v46, v61
  v_fmac_f32 v70, v46, v62
  v_fmac_f32 v71, v46, v63
  s_waitcnt vmcnt(2)
  v_lshlrev_b32 v56, 16, v108
  v_and_b32 v57, 0xffff0000, v108
  v_lshlrev_b32 v58, 16, v109
  v_and_b32 v59, 0xffff0000, v109
  v_lshlrev_b32 v60, 16, v110
  v_and_b32 v61, 0xffff0000, v110
  v_lshlrev_b32 v62, 16, v111
  v_and_b32 v63, 0xffff0000, v111
  v_fmac_f32 v64, v47, v56
  v_fmac_f32 v65, v47, v57
  v_fmac_f32 v66, v47, v58
  v_fmac_f32 v67, v47, v59
  v_fmac_f32 v68, v47, v60
  v_fmac_f32 v69, v47, v61
  v_fmac_f32 v70, v47, v62
  v_fmac_f32 v71, v47, v63
  v_permlane32_swap_b32 v64, v68
  v_permlane32_swap_b32 v65, v69
  v_permlane32_swap_b32 v66, v70
  v_permlane32_swap_b32 v67, v71
  v_add_f32 v64, v64, v68
  v_add_f32 v65, v65, v69
  v_add_f32 v66, v66, v70
  v_add_f32 v67, v67, v71
  s_nop 0
  v_permlane16_swap_b32 v64, v66
  v_permlane16_swap_b32 v65, v67
  v_add_f32 v64, v64, v66
  v_add_f32 v65, v65, v67
  s_nop 0
  v_add_f32_dpp v64, v64, v64 row_ror:8 row_mask:0xf bank_mask:0xf
  v_add_f32_dpp v65, v65, v65 row_ror:8 row_mask:0xf bank_mask:0xf
  ds_write_b64 v24, v[64:65] offset:0
  s_waitcnt lgkmcnt(0)
  s_barrier
  v_add_u32 v14, s29, v14
  v_add_u32 v15, s29, v15
  v_add_u32 v16, s29, v16
  v_add_u32 v18, s29, v18
  s_waitcnt vmcnt(0)
  s_barrier
  global_load_dwordx2 v[40:41], v40, s[50:51]
  global_load_dwordx4 v[112:115], v14, s[52:53]
  global_load_dwordx4 v[116:119], v15, s[52:53]
  global_load_dwordx4 v[120:123], v16, s[52:53]
  global_load_dwordx4 v[124:127], v18, s[52:53]
  v_add_u32 v14, s31, v14
  v_add_u32 v15, s31, v15
  v_add_u32 v16, s31, v16
  v_add_u32 v18, s31, v18
  global_load_dwordx4 v[128:131], v14, s[52:53]
  global_load_dwordx4 v[132:135], v15, s[52:53]
  global_load_dwordx4 v[136:139], v16, s[52:53]
  global_load_dwordx4 v[140:143], v18, s[52:53]
  s_waitcnt vmcnt(8)
  v_lshlrev_b32 v36, 16, v40
  v_and_b32 v37, 0xffff0000, v40
  v_lshlrev_b32 v38, 16, v41
  v_and_b32 v39, 0xffff0000, v41
  v_mul_f32 v48, s27, v36
  v_mul_f32 v49, s27, v37
  v_mul_f32 v50, s27, v38
  v_mul_f32 v51, s27, v39
  v_exp_f32 v48, v48
  v_exp_f32 v49, v49
  v_exp_f32 v50, v50
  v_exp_f32 v51, v51
  v_add_f32 v48, 1.0, v48
  v_add_f32 v49, 1.0, v49
  v_add_f32 v50, 1.0, v50
  v_add_f32 v51, 1.0, v51
  v_rcp_f32 v48, v48
  v_rcp_f32 v49, v49
  v_rcp_f32 v50, v50
  v_rcp_f32 v51, v51
  v_mul_f32 v36, v36, v48
  v_mul_f32 v37, v37, v49
  v_mul_f32 v38, v38, v50
  v_mul_f32 v39, v39, v51
  v_cvt_pk_bf16_f32 v48, v36, v37
  v_cvt_pk_bf16_f32 v49, v38, v39
  v_lshlrev_b32 v36, 16, v48
  v_and_b32 v37, 0xffff0000, v48
  v_lshlrev_b32 v38, 16, v49
  v_and_b32 v39, 0xffff0000, v49
  s_waitcnt vmcnt(7)
  v_lshlrev_b32 v56, 16, v112
  v_and_b32 v57, 0xffff0000, v112
  v_lshlrev_b32 v58, 16, v113
  v_and_b32 v59, 0xffff0000, v113
  v_lshlrev_b32 v60, 16, v114
  v_and_b32 v61, 0xffff0000, v114
  v_lshlrev_b32 v62, 16, v115
  v_and_b32 v63, 0xffff0000, v115
  v_mul_f32 v64, v44, v56
  v_mul_f32 v65, v44, v57
  v_mul_f32 v66, v44, v58
  v_mul_f32 v67, v44, v59
  v_mul_f32 v68, v44, v60
  v_mul_f32 v69, v44, v61
  v_mul_f32 v70, v44, v62
  v_mul_f32 v71, v44, v63
  s_waitcnt vmcnt(6)
  v_lshlrev_b32 v56, 16, v116
  v_and_b32 v57, 0xffff0000, v116
  v_lshlrev_b32 v58, 16, v117
  v_and_b32 v59, 0xffff0000, v117
  v_lshlrev_b32 v60, 16, v118
  v_and_b32 v61, 0xffff0000, v118
  v_lshlrev_b32 v62, 16, v119
  v_and_b32 v63, 0xffff0000, v119
  v_fmac_f32 v64, v45, v56
  v_fmac_f32 v65, v45, v57
  v_fmac_f32 v66, v45, v58
  v_fmac_f32 v67, v45, v59
  v_fmac_f32 v68, v45, v60
  v_fmac_f32 v69, v45, v61
  v_fmac_f32 v70, v45, v62
  v_fmac_f32 v71, v45, v63
  s_waitcnt vmcnt(5)
  v_lshlrev_b32 v56, 16, v120
  v_and_b32 v57, 0xffff0000, v120
  v_lshlrev_b32 v58, 16, v121
  v_and_b32 v59, 0xffff0000, v121
  v_lshlrev_b32 v60, 16, v122
  v_and_b32 v61, 0xffff0000, v122
  v_lshlrev_b32 v62, 16, v123
  v_and_b32 v63, 0xffff0000, v123
  v_fmac_f32 v64, v46, v56
  v_fmac_f32 v65, v46, v57
  v_fmac_f32 v66, v46, v58
  v_fmac_f32 v67, v46, v59
  v_fmac_f32 v68, v46, v60
  v_fmac_f32 v69, v46, v61
  v_fmac_f32 v70, v46, v62
  v_fmac_f32 v71, v46, v63
  s_waitcnt vmcnt(4)
  v_lshlrev_b32 v56, 16, v124
  v_and_b32 v57, 0xffff0000, v124
  v_lshlrev_b32 v58, 16, v125
  v_and_b32 v59, 0xffff0000, v125
  v_lshlrev_b32 v60, 16, v126
  v_and_b32 v61, 0xffff0000, v126
  v_lshlrev_b32 v62, 16, v127
  v_and_b32 v63, 0xffff0000, v127
  v_fmac_f32 v64, v47, v56
  v_fmac_f32 v65, v47, v57
  v_fmac_f32 v66, v47, v58
  v_fmac_f32 v67, v47, v59
  v_fmac_f32 v68, v47, v60
  v_fmac_f32 v69, v47, v61
  v_fmac_f32 v70, v47, v62
  v_fmac_f32 v71, v47, v63
  s_waitcnt vmcnt(3)
  v_lshlrev_b32 v56, 16, v128
  v_and_b32 v57, 0xffff0000, v128
  v_lshlrev_b32 v58, 16, v129
  v_and_b32 v59, 0xffff0000, v129
  v_lshlrev_b32 v60, 16, v130
  v_and_b32 v61, 0xffff0000, v130
  v_lshlrev_b32 v62, 16, v131
  v_and_b32 v63, 0xffff0000, v131
  v_fmac_f32 v64, v36, v56
  v_fmac_f32 v65, v36, v57
  v_fmac_f32 v66, v36, v58
  v_fmac_f32 v67, v36, v59
  v_fmac_f32 v68, v36, v60
  v_fmac_f32 v69, v36, v61
  v_fmac_f32 v70, v36, v62
  v_fmac_f32 v71, v36, v63
  s_waitcnt vmcnt(2)
  v_lshlrev_b32 v56, 16, v132
  v_and_b32 v57, 0xffff0000, v132
  v_lshlrev_b32 v58, 16, v133
  v_and_b32 v59, 0xffff0000, v133
  v_lshlrev_b32 v60, 16, v134
  v_and_b32 v61, 0xffff0000, v134
  v_lshlrev_b32 v62, 16, v135
  v_and_b32 v63, 0xffff0000, v135
  v_fmac_f32 v64, v37, v56
  v_fmac_f32 v65, v37, v57
  v_fmac_f32 v66, v37, v58
  v_fmac_f32 v67, v37, v59
  v_fmac_f32 v68, v37, v60
  v_fmac_f32 v69, v37, v61
  v_fmac_f32 v70, v37, v62
  v_fmac_f32 v71, v37, v63
  s_waitcnt vmcnt(1)
  v_lshlrev_b32 v56, 16, v136
  v_and_b32 v57, 0xffff0000, v136
  v_lshlrev_b32 v58, 16, v137
  v_and_b32 v59, 0xffff0000, v137
  v_lshlrev_b32 v60, 16, v138
  v_and_b32 v61, 0xffff0000, v138
  v_lshlrev_b32 v62, 16, v139
  v_and_b32 v63, 0xffff0000, v139
  v_fmac_f32 v64, v38, v56
  v_fmac_f32 v65, v38, v57
  v_fmac_f32 v66, v38, v58
  v_fmac_f32 v67, v38, v59
  v_fmac_f32 v68, v38, v60
  v_fmac_f32 v69, v38, v61
  v_fmac_f32 v70, v38, v62
  v_fmac_f32 v71, v38, v63
  s_waitcnt vmcnt(0)
  v_lshlrev_b32 v56, 16, v140
  v_and_b32 v57, 0xffff0000, v140
  v_lshlrev_b32 v58, 16, v141
  v_and_b32 v59, 0xffff0000, v141
  v_lshlrev_b32 v60, 16, v142
  v_and_b32 v61, 0xffff0000, v142
  v_lshlrev_b32 v62, 16, v143
  v_and_b32 v63, 0xffff0000, v143
  v_fmac_f32 v64, v39, v56
  v_fmac_f32 v65, v39, v57
  v_fmac_f32 v66, v39, v58
  v_fmac_f32 v67, v39, v59
  v_fmac_f32 v68, v39, v60
  v_fmac_f32 v69, v39, v61
  v_fmac_f32 v70, v39, v62
  v_fmac_f32 v71, v39, v63
  v_permlane32_swap_b32 v64, v68
  v_permlane32_swap_b32 v65, v69
  v_permlane32_swap_b32 v66, v70
  v_permlane32_swap_b32 v67, v71
  v_add_f32 v64, v64, v68
  v_add_f32 v65, v65, v69
  v_add_f32 v66, v66, v70
  v_add_f32 v67, v67, v71
  s_nop 0
  v_permlane16_swap_b32 v64, v66
  v_permlane16_swap_b32 v65, v67
  v_add_f32 v64, v64, v66
  v_add_f32 v65, v65, v67
  s_nop 0
  v_add_f32_dpp v64, v64, v64 row_ror:8 row_mask:0xf bank_mask:0xf
  v_add_f32_dpp v65, v65, v65 row_ror:8 row_mask:0xf bank_mask:0xf
  ds_write_b64 v24, v[64:65] offset:4096
  s_mul_i32 s3, s24, 35840
  s_add_u32 s3, s3, 458752
  v_min_u32 v80, 279, v0
  v_lshl_add_u32 v80, v80, 7, s3
  global_load_dword v80, v80, s[44:45]
  s_waitcnt lgkmcnt(0)
  s_barrier
  s_branch F_sst
F_spare7:
  ds_read_b128 v[160:163], v31
  s_waitcnt lgkmcnt(0)
  s_mov_b64 exec, 15
  global_store_dwordx4 v9, v[160:163], s[20:21] sc1
  s_mov_b64 exec, -1
  s_barrier
  ds_read_b32 v72, v26 offset:0
  ds_read_b32 v73, v26 offset:256
  ds_read_b32 v74, v26 offset:512
  ds_read_b32 v75, v26 offset:768
  ds_read_b32 v76, v26 offset:1024
  ds_read_b32 v77, v26 offset:1280
  ds_read_b32 v78, v26 offset:1536
  s_waitcnt lgkmcnt(0)
  v_add_f32 v72, v72, v73
  v_add_f32 v74, v74, v75
  v_add_f32 v76, v76, v77
  v_add_f32 v72, v72, v74
  v_add_f32 v76, v76, v78
  v_add_f32 v72, v72, v76
  v_mov_b32 v73, v33
  global_store_dwordx2 v25, v[72:73], s[20:21] sc1
  s_lshl_b32 s3, s2, 7
  s_add_u32 s3, s3, 65536
  v_mov_b32 v9, s3
  s_mov_b64 exec, 1
  s_barrier
  global_store_dword v9, v33, s[20:21] sc1
  s_mov_b64 exec, -1
  s_lshl_b32 s3, s30, 8
  s_add_u32 s3, s3, 1851392
  v_add_u32 v25, s3, v26
  s_sub_u32 s3, s30, 14
  s_cmp_lt_u32 s3, 7
  s_cselect_b32 s3, 1.0, 0
  s_mov_b32 s56, 0x55555555
  s_mov_b32 s57, 0x55555555
  s_barrier
  ds_read_b32 v72, v26 offset:4096
  ds_read_b32 v73, v26 offset:4352
  ds_read_b32 v74, v26 offset:4608
  ds_read_b32 v75, v26 offset:4864
  ds_read_b32 v76, v26 offset:5120
  ds_read_b32 v77, v26 offset:5376
  ds_read_b32 v78, v26 offset:5632
  s_waitcnt lgkmcnt(0)
  v_add_f32 v72, v72, v73
  v_add_f32 v74, v74, v75
  v_add_f32 v76, v76, v77
  v_add_f32 v72, v72, v74
  v_add_f32 v76, v76, v78
  v_add_f32 v72, v72, v76
  v_cvt_pk_bf16_f32 v72, v72, v72
  v_and_b32 v72, 0xffff0000, v72
  v_add_f32 v72, s3, v72
  v_mov_b32 v73, 0x21800000
  v_cmp_neq_f32 vcc, 0, v72
  v_mul_f32 v73, s3, v73
  s_nop 0
  v_cndmask_b32 v72, v73, v72, vcc
  v_mov_b32 v73, v33
  s_nop 0
  v_mov_b32_dpp v74, v72 quad_perm:[1,0,3,2] row_mask:0xf bank_mask:0xf
  v_cvt_pk_bf16_f32 v72, v72, v74
  s_mov_b64 exec, s[56:57]
  global_store_dwordx2 v25, v[72:73], s[20:21] sc1
  s_mov_b64 exec, -1
F_sst:
  s_and_b32 s3, s24, 24
  s_add_u32 s3, s3, s33
  s_lshl_b32 s26, s3, 2
  v_lshrrev_b32 v12, 4, v2
  v_add_u32 v12, s26, v12
  v_and_b32 v14, 15, v2
  v_min_u32 v14, 13, v14
  s_bfe_u32 s26, s2, 0x10002
  s_mul_i32 s26, s26, 1792
  v_lshl_add_u32 v14, v14, 7, s26
  s_min_u32 s3, s3, 27
  s_cmp_ge_u32 s3, 14
  s_cselect_b32 s26, 1604608, 0
  s_mul_i32 s3, s3, 114688
  s_sub_u32 s3, s3, s26
  s_add_u32 s3, s3, 10485760
  v_lshrrev_b32 v15, 3, v2
  v_mul_u32_u24 v15, 14336, v15
  v_and_b32 v13, 7, v2
  v_lshl_add_u32 v15, v13, 7, v15
  v_add_u32 v15, s3, v15
  s_and_b32 s3, s24, 3
  s_lshr_b32 s26, s24, 3
  s_lshl2_add_u32 s3, s3, s26
  s_bfe_u32 s24, s24, 0x10002
  s_lshl1_add_u32 s24, s3, s24
  s_lshl_b32 s3, s24, 7
  s_add_u32 s3, s3, 1933312
  v_mov_b32 v4, s3
  s_and_b32 s3, s24, 30
  s_add_u32 s24, s24, s3
  s_lshl1_add_u32 s24, s38, s24
  s_mul_i32 s3, s24, 57344
  s_and_b32 s25, s33, 3
  s_mul_i32 s26, s25, 3584
  s_add_u32 s3, s3, s26
  s_add_u32 s3, s3, 20971520
  v_and_b32 v5, 3, v2
  v_lshl_add_u32 v5, v5, 4, s3
  v_lshrrev_b32 v7, 3, v2
  v_lshl_add_u32 v5, v7, 6, v5
  v_bfe_u32 v7, v2, 2, 1
  v_mul_u32_u24 v7, 28672, v7
  v_add_u32 v5, v5, v7
  v_lshrrev_b32 v7, 5, v2
  v_lshlrev_b32 v7, 4, v7
  v_and_b32 v8, 7, v2
  v_lshl_add_u32 v24, v8, 5, v7
  v_bfe_u32 v8, v2, 4, 1
  v_lshl_add_u32 v24, v8, 3, v24
  s_lshl_b32 s3, s33, 8
  s_add_u32 s3, s3, 8192
  v_add_u32 v24, s3, v24
  v_bfe_u32 v8, v2, 2, 3
  v_lshl_add_u32 v7, v8, 5, v7
  v_and_b32 v8, 3, v2
  v_lshl_add_u32 v7, v8, 2, v7
  v_add_u32 v7, s3, v7
  s_lshl_b32 s3, s24, 9
  s_add_u32 s3, s3, 1867776
  v_lshl_add_u32 v6, v2, 3, s3
  v_cmp_gt_u32 s[56:57], 32, v2
  s_mul_i32 s3, s25, 448
  s_add_u32 s3, s3, 1854976
  v_and_b32 v8, 56, v2
  v_add_u32 v8, s3, v8
F_sg:
  s_add_u32 s43, s43, 1
  s_cmp_gt_u32 s43, 4000000
  s_cbranch_scc1 F_sh
  global_load_dwordx2 v[144:145], v8, s[20:21] offset:0 sc1
  global_load_dwordx2 v[146:147], v8, s[20:21] offset:64 sc1
  global_load_dwordx2 v[148:149], v8, s[20:21] offset:128 sc1
  global_load_dwordx2 v[150:151], v8, s[20:21] offset:192 sc1
  global_load_dwordx2 v[152:153], v8, s[20:21] offset:256 sc1
  global_load_dwordx2 v[154:155], v8, s[20:21] offset:320 sc1
  global_load_dwordx2 v[156:157], v8, s[20:21] offset:384 sc1
  s_waitcnt vmcnt(0)
  v_xor_b32 v145, s40, v145
  v_xor_b32 v147, s40, v147
  v_xor_b32 v149, s40, v149
  v_xor_b32 v151, s40, v151
  v_xor_b32 v153, s40, v153
  v_xor_b32 v155, s40, v155
  v_xor_b32 v157, s40, v157
  v_or3_b32 v145, v145, v147, v149
  v_or3_b32 v145, v145, v151, v153
  v_or3_b32 v145, v145, v155, v157
  v_cmp_ne_u32 vcc, 0, v145
  s_cbranch_vccnz F_sg
F_sh:
  v_and_b32 v145, 0xffff0000, v144
  v_lshlrev_b32 v144, 16, v144
  v_and_b32 v147, 0xffff0000, v146
  v_lshlrev_b32 v146, 16, v146
  v_and_b32 v149, 0xffff0000, v148
  v_lshlrev_b32 v148, 16, v148
  v_and_b32 v151, 0xffff0000, v150
  v_lshlrev_b32 v150, 16, v150
  v_and_b32 v153, 0xffff0000, v152
  v_lshlrev_b32 v152, 16, v152
  v_and_b32 v155, 0xffff0000, v154
  v_lshlrev_b32 v154, 16, v154
  v_and_b32 v157, 0xffff0000, v156
  v_lshlrev_b32 v156, 16, v156
  v_rcp_f32 v144, v144
  v_rcp_f32 v145, v145
  v_rcp_f32 v146, v146
  v_rcp_f32 v147, v147
  v_rcp_f32 v148, v148
  v_rcp_f32 v149, v149
  v_rcp_f32 v150, v150
  v_rcp_f32 v151, v151
  v_rcp_f32 v152, v152
  v_rcp_f32 v153, v153
  v_rcp_f32 v154, v154
  v_rcp_f32 v155, v155
  v_rcp_f32 v156, v156
  v_rcp_f32 v157, v157
  s_cmp_lg_u32 s33, 0
  s_cbranch_scc1 F_s1
F_s0:
  s_add_u32 s43, s43, 1
  s_cmp_gt_u32 s43, 4000000
  s_cbranch_scc1 F_s1
  s_sleep 2
  global_load_dword v10, v4, s[20:21] sc1
  s_waitcnt vmcnt(0)
  v_cmp_ne_u32 vcc, s40, v10
  s_cbranch_vccnz F_s0
F_s1:
  s_barrier
  s_cmp_lg_u32 s38, 1
  s_cbranch_scc1 F_on8
  s_barrier
F_on8:
  global_load_dwordx4 v[96:99], v5, s[20:21] offset:0 sc1
  global_load_dwordx4 v[100:103], v5, s[20:21] offset:512 sc1
  global_load_dwordx4 v[104:107], v5, s[20:21] offset:1024 sc1
  global_load_dwordx4 v[108:111], v5, s[20:21] offset:1536 sc1
  global_load_dwordx4 v[112:115], v5, s[20:21] offset:2048 sc1
  global_load_dwordx4 v[116:119], v5, s[20:21] offset:2560 sc1
  global_load_dwordx4 v[120:123], v5, s[20:21] offset:3072 sc1
  s_barrier
F_s5:
  s_waitcnt vmcnt(6)
  v_lshlrev_b32 v72, 16, v96
  v_and_b32 v73, 0xffff0000, v96
  v_lshlrev_b32 v74, 16, v97
  v_and_b32 v75, 0xffff0000, v97
  v_pk_mul_f32 v[64:65], v[144:145], v[72:73] op_sel_hi:[0,1]
  v_pk_mul_f32 v[66:67], v[144:145], v[74:75] op_sel_hi:[0,1]
  v_pk_mul_f32 v[68:69], v[64:65], v[64:65]
  v_pk_mul_f32 v[70:71], v[66:67], v[66:67]
  v_lshlrev_b32 v76, 16, v98
  v_and_b32 v77, 0xffff0000, v98
  v_lshlrev_b32 v78, 16, v99
  v_and_b32 v79, 0xffff0000, v99
  v_pk_mul_f32 v[76:77], v[144:145], v[76:77] op_sel:[1,0]
  v_pk_mul_f32 v[78:79], v[144:145], v[78:79] op_sel:[1,0]
  v_pk_add_f32 v[64:65], v[64:65], v[76:77]
  v_pk_fma_f32 v[68:69], v[76:77], v[76:77], v[68:69]
  v_pk_add_f32 v[66:67], v[66:67], v[78:79]
  v_pk_fma_f32 v[70:71], v[78:79], v[78:79], v[70:71]
  s_waitcnt vmcnt(5)
  v_lshlrev_b32 v72, 16, v100
  v_and_b32 v73, 0xffff0000, v100
  v_lshlrev_b32 v74, 16, v101
  v_and_b32 v75, 0xffff0000, v101
  v_pk_mul_f32 v[72:73], v[146:147], v[72:73] op_sel_hi:[0,1]
  v_pk_mul_f32 v[74:75], v[146:147], v[74:75] op_sel_hi:[0,1]
  v_pk_add_f32 v[64:65], v[64:65], v[72:73]
  v_pk_fma_f32 v[68:69], v[72:73], v[72:73], v[68:69]
  v_pk_add_f32 v[66:67], v[66:67], v[74:75]
  v_pk_fma_f32 v[70:71], v[74:75], v[74:75], v[70:71]
  v_lshlrev_b32 v76, 16, v102
  v_and_b32 v77, 0xffff0000, v102
  v_lshlrev_b32 v78, 16, v103
  v_and_b32 v79, 0xffff0000, v103
  v_pk_mul_f32 v[76:77], v[146:147], v[76:77] op_sel:[1,0]
  v_pk_mul_f32 v[78:79], v[146:147], v[78:79] op_sel:[1,0]
  v_pk_add_f32 v[64:65], v[64:65], v[76:77]
  v_pk_fma_f32 v[68:69], v[76:77], v[76:77], v[68:69]
  v_pk_add_f32 v[66:67], v[66:67], v[78:79]
  v_pk_fma_f32 v[70:71], v[78:79], v[78:79], v[70:71]
  s_waitcnt vmcnt(4)
  v_lshlrev_b32 v72, 16, v104
  v_and_b32 v73, 0xffff0000, v104
  v_lshlrev_b32 v74, 16, v105
  v_and_b32 v75, 0xffff0000, v105
  v_pk_mul_f32 v[72:73], v[148:149], v[72:73] op_sel_hi:[0,1]
  v_pk_mul_f32 v[74:75], v[148:149], v[74:75] op_sel_hi:[0,1]
  v_pk_add_f32 v[64:65], v[64:65], v[72:73]
  v_pk_fma_f32 v[68:69], v[72:73], v[72:73], v[68:69]
  v_pk_add_f32 v[66:67], v[66:67], v[74:75]
  v_pk_fma_f32 v[70:71], v[74:75], v[74:75], v[70:71]
  v_lshlrev_b32 v76, 16, v106
  v_and_b32 v77, 0xffff0000, v106
  v_lshlrev_b32 v78, 16, v107
  v_and_b32 v79, 0xffff0000, v107
  v_pk_mul_f32 v[76:77], v[148:149], v[76:77] op_sel:[1,0]
  v_pk_mul_f32 v[78:79], v[148:149], v[78:79] op_sel:[1,0]
  v_pk_add_f32 v[64:65], v[64:65], v[76:77]
  v_pk_fma_f32 v[68:69], v[76:77], v[76:77], v[68:69]
  v_pk_add_f32 v[66:67], v[66:67], v[78:79]
  v_pk_fma_f32 v[70:71], v[78:79], v[78:79], v[70:71]
  s_waitcnt vmcnt(3)
  v_lshlrev_b32 v72, 16, v108
  v_and_b32 v73, 0xffff0000, v108
  v_lshlrev_b32 v74, 16, v109
  v_and_b32 v75, 0xffff0000, v109
  v_pk_mul_f32 v[72:73], v[150:151], v[72:73] op_sel_hi:[0,1]
  v_pk_mul_f32 v[74:75], v[150:151], v[74:75] op_sel_hi:[0,1]
  v_pk_add_f32 v[64:65], v[64:65], v[72:73]
  v_pk_fma_f32 v[68:69], v[72:73], v[72:73], v[68:69]
  v_pk_add_f32 v[66:67], v[66:67], v[74:75]
  v_pk_fma_f32 v[70:71], v[74:75], v[74:75], v[70:71]
  v_lshlrev_b32 v76, 16, v110
  v_and_b32 v77, 0xffff0000, v110
  v_lshlrev_b32 v78, 16, v111
  v_and_b32 v79, 0xffff0000, v111
  v_pk_mul_f32 v[76:77], v[150:151], v[76:77] op_sel:[1,0]
  v_pk_mul_f32 v[78:79], v[150:151], v[78:79] op_sel:[1,0]
  v_pk_add_f32 v[64:65], v[64:65], v[76:77]
  v_pk_fma_f32 v[68:69], v[76:77], v[76:77], v[68:69]
  v_pk_add_f32 v[66:67], v[66:67], v[78:79]
  v_pk_fma_f32 v[70:71], v[78:79], v[78:79], v[70:71]
  s_waitcnt vmcnt(2)
  v_lshlrev_b32 v72, 16, v112
  v_and_b32 v73, 0xffff0000, v112
  v_lshlrev_b32 v74, 16, v113
  v_and_b32 v75, 0xffff0000, v113
  v_pk_mul_f32 v[72:73], v[152:153], v[72:73] op_sel_hi:[0,1]
  v_pk_mul_f32 v[74:75], v[152:153], v[74:75] op_sel_hi:[0,1]
  v_pk_add_f32 v[64:65], v[64:65], v[72:73]
  v_pk_fma_f32 v[68:69], v[72:73], v[72:73], v[68:69]
  v_pk_add_f32 v[66:67], v[66:67], v[74:75]
  v_pk_fma_f32 v[70:71], v[74:75], v[74:75], v[70:71]
  v_lshlrev_b32 v76, 16, v114
  v_and_b32 v77, 0xffff0000, v114
  v_lshlrev_b32 v78, 16, v115
  v_and_b32 v79, 0xffff0000, v115
  v_pk_mul_f32 v[76:77], v[152:153], v[76:77] op_sel:[1,0]
  v_pk_mul_f32 v[78:79], v[152:153], v[78:79] op_sel:[1,0]
  v_pk_add_f32 v[64:65], v[64:65], v[76:77]
  v_pk_fma_f32 v[68:69], v[76:77], v[76:77], v[68:69]
  v_pk_add_f32 v[66:67], v[66:67], v[78:79]
  v_pk_fma_f32 v[70:71], v[78:79], v[78:79], v[70:71]
  s_waitcnt vmcnt(1)
  v_lshlrev_b32 v72, 16, v116
  v_and_b32 v73, 0xffff0000, v116
  v_lshlrev_b32 v74, 16, v117
  v_and_b32 v75, 0xffff0000, v117
  v_pk_mul_f32 v[72:73], v[154:155], v[72:73] op_sel_hi:[0,1]
  v_pk_mul_f32 v[74:75], v[154:155], v[74:75] op_sel_hi:[0,1]
  v_pk_add_f32 v[64:65], v[64:65], v[72:73]
  v_pk_fma_f32 v[68:69], v[72:73], v[72:73], v[68:69]
  v_pk_add_f32 v[66:67], v[66:67], v[74:75]
  v_pk_fma_f32 v[70:71], v[74:75], v[74:75], v[70:71]
  v_lshlrev_b32 v76, 16, v118
  v_and_b32 v77, 0xffff0000, v118
  v_lshlrev_b32 v78, 16, v119
  v_and_b32 v79, 0xffff0000, v119
  v_pk_mul_f32 v[76:77], v[154:155], v[76:77] op_sel:[1,0]
  v_pk_mul_f32 v[78:79], v[154:155], v[78:79] op_sel:[1,0]
  v_pk_add_f32 v[64:65], v[64:65], v[76:77]
  v_pk_fma_f32 v[68:69], v[76:77], v[76:77], v[68:69]
  v_pk_add_f32 v[66:67], v[66:67], v[78:79]
  v_pk_fma_f32 v[70:71], v[78:79], v[78:79], v[70:71]
  s_waitcnt vmcnt(0)
  v_lshlrev_b32 v72, 16, v120
  v_and_b32 v73, 0xffff0000, v120
  v_lshlrev_b32 v74, 16, v121
  v_and_b32 v75, 0xffff0000, v121
  v_pk_mul_f32 v[72:73], v[156:157], v[72:73] op_sel_hi:[0,1]
  v_pk_mul_f32 v[74:75], v[156:157], v[74:75] op_sel_hi:[0,1]
  v_pk_add_f32 v[64:65], v[64:65], v[72:73]
  v_pk_fma_f32 v[68:69], v[72:73], v[72:73], v[68:69]
  v_pk_add_f32 v[66:67], v[66:67], v[74:75]
  v_pk_fma_f32 v[70:71], v[74:75], v[74:75], v[70:71]
  v_lshlrev_b32 v76, 16, v122
  v_and_b32 v77, 0xffff0000, v122
  v_lshlrev_b32 v78, 16, v123
  v_and_b32 v79, 0xffff0000, v123
  v_pk_mul_f32 v[76:77], v[156:157], v[76:77] op_sel:[1,0]
  v_pk_mul_f32 v[78:79], v[156:157], v[78:79] op_sel:[1,0]
  v_pk_add_f32 v[64:65], v[64:65], v[76:77]
  v_pk_fma_f32 v[68:69], v[76:77], v[76:77], v[68:69]
  v_pk_add_f32 v[66:67], v[66:67], v[78:79]
  v_pk_fma_f32 v[70:71], v[78:79], v[78:79], v[70:71]
  v_max3_u32 v10, v97, v101, v105
  v_max3_u32 v11, v109, v113, v117
  v_max3_u32 v10, v10, v11, v121
  v_cmp_le_u32 vcc, 0xffff0000, v10
  s_cbranch_vccnz F_s3
F_s4:
  v_permlane32_swap_b32 v64, v68
  v_permlane32_swap_b32 v65, v69
  v_permlane32_swap_b32 v66, v70
  v_permlane32_swap_b32 v67, v71
  v_add_f32 v64, v64, v68
  v_add_f32 v65, v65, v69
  v_add_f32 v66, v66, v70
  v_add_f32 v67, v67, v71
  s_nop 0
  v_permlane16_swap_b32 v64, v66
  v_permlane16_swap_b32 v65, v67
  v_add_f32 v64, v64, v66
  v_add_f32 v65, v65, v67
  s_nop 0
  v_add_f32_dpp v64, v64, v64 row_ror:8 row_mask:0xf bank_mask:0xf
  v_add_f32_dpp v65, v65, v65 row_ror:8 row_mask:0xf bank_mask:0xf
  ds_write_b64 v24, v[64:65]
  s_cmp_lg_u32 s25, 0
  s_waitcnt lgkmcnt(0)
  s_barrier
  s_cbranch_scc1 F_s7
  ds_read2st64_b32 v[20:21], v7 offset0:0 offset1:1
  ds_read2st64_b32 v[22:23], v7 offset0:2 offset1:3
  s_waitcnt lgkmcnt(0)
  v_add_f32 v20, v20, v21
  v_add_f32 v22, v22, v23
  v_add_f32 v20, v20, v22
  v_mul_f32 v20, 0x3b124925, v20
  v_mov_b32 v22, v20
  s_nop 1
  v_permlane32_swap_b32 v20, v22
  v_fma_f32 v22, -v20, v20, v22
  v_max_f32 v22, 0, v22
  v_cvt_pk_bf16_f32 v22, v22, v22
  v_and_b32 v22, 0xffff0000, v22
  v_add_f32 v22, 0x3727c5ac, v22
  v_cvt_pk_bf16_f32 v22, v22, v22
  v_and_b32 v22, 0xffff0000, v22
  v_sqrt_f32 v22, v22
  v_cvt_pk_bf16_f32 v20, -v20, -v20
  v_cvt_pk_bf16_f32 v22, v22, v22
  v_cndmask_b32 v32, v22, v20, s[56:57]
  global_store_dwordx2 v6, v[32:33], s[20:21] sc1
F_s7:
  s_cmp_lg_u32 s38, 0
  s_cbranch_scc1 F_on9
  s_barrier
F_on9:
  s_waitcnt vmcnt(0)
  s_endpgm
F_s3:
  s_add_u32 s43, s43, 1
  s_cmp_gt_u32 s43, 4000000
  s_cbranch_scc1 F_s4
  s_mov_b64 exec, vcc
  global_load_dwordx4 v[96:99], v5, s[20:21] offset:0 sc1
  global_load_dwordx4 v[100:103], v5, s[20:21] offset:512 sc1
  global_load_dwordx4 v[104:107], v5, s[20:21] offset:1024 sc1
  global_load_dwordx4 v[108:111], v5, s[20:21] offset:1536 sc1
  global_load_dwordx4 v[112:115], v5, s[20:21] offset:2048 sc1
  global_load_dwordx4 v[116:119], v5, s[20:21] offset:2560 sc1
  global_load_dwordx4 v[120:123], v5, s[20:21] offset:3072 sc1
  s_mov_b64 exec, -1
  s_branch F_s5
F_end:
  s_endpgm
.p2align 4
.type ktab,@object
ktab:
.short 128, 128, 128, 128, 128, 0, 0, 0, 128, 128, 128, 128, 128, 8, 0, 0
.short 128, 128, 128, 128, 128, 16, 0, 0, 128, 128, 128, 128, 128, 24, 0, 0
.short 128, 128, 128, 128, 128, 32, 0, 0, 128, 128, 128, 128, 128, 40, 0, 0
.short 128, 128, 128, 128, 128, 48, 0, 0, 128, 12480, 12480, 12480, 12480, 56, 0, 0
.short 12480, 11564, 10524, 10524, 10524, 64, 0, 0, 10524, 9484, 8444, 8444, 8444, 72, 0, 0
.short 8444, 11560, 10520, 10520, 10520, 80, 0, 0, 10520, 9480, 8440, 8440, 8440, 88, 0, 0
.short 8440, 11556, 10516, 10516, 10516, 96, 0, 0, 10516, 9476, 8436, 8436, 8436, 104, 0, 0
.short 8436, 11552, 10512, 10512, 10512, 112, 0, 0, 10512, 9472, 8432, 8432, 8432, 120, 0, 0
.short 8432, 11548, 10508, 10508, 10508, 128, 0, 0, 10508, 9468, 8428, 8428, 8428, 136, 0, 0
.short 8428, 11544, 10504, 10504, 10504, 144, 0, 0, 10504, 9464, 8424, 8424, 8424, 152, 0, 0
.short 8424, 11540, 10500, 10500, 10500, 160, 0, 0, 10500, 9460, 8420, 8420, 8420, 168, 0, 0
.short 8420, 11536, 10496, 10496, 10496, 176, 0, 0, 10496, 9456, 8416, 8416, 8416, 184, 0, 0
.short 8416, 11532, 10492, 10492, 10492, 192, 0, 0, 10492, 9452, 8412, 8412, 8412, 200, 0, 0
.short 8412, 11528, 10488, 10488, 10488, 208, 0, 0, 10488, 9448, 8408, 8408, 8408, 216, 0, 0
.short 8408, 11524, 10484, 10484, 10484, 224, 0, 0, 10484, 9444, 8404, 8404, 8404, 232, 0, 0
.short 8404, 11520, 10480, 10480, 10480, 240, 0, 0, 10480, 9440, 8400, 8400, 8400, 248, 0, 0
.short 8400, 11516, 10476, 10476, 10476, 256, 0, 0, 10476, 9436, 8396, 8396, 8396, 264, 0, 0
.short 8396, 11512, 10472, 10472, 10472, 272, 0, 0, 10472, 9432, 8392, 8392, 8392, 280, 0, 0
.short 8392, 11508, 10468, 10468, 10468, 288, 0, 0, 10468, 9428, 8388, 8388, 8388, 296, 0, 0
.short 8388, 11504, 10464, 10464, 10464, 304, 0, 0, 10464, 9424, 8384, 8384, 8384, 312, 0, 0
.short 8384, 11500, 10460, 10460, 10460, 320, 0, 0, 10460, 9420, 8380, 8380, 8380, 328, 0, 0
.short 8380, 11496, 10456, 10456, 10456, 336, 0, 0, 10456, 9416, 8376, 8376, 8376, 344, 0, 0
.short 8376, 11492, 10452, 10452, 10452, 352, 0, 0, 10452, 9412, 8372, 8372, 8372, 360, 0, 0
.short 8372, 11488, 10448, 10448, 10448, 368, 0, 0, 10448, 9408, 8368, 8368, 8368, 376, 0, 0
.short 8368, 11484, 10444, 10444, 10444, 384, 0, 0, 10444, 9404, 8364, 8364, 8364, 392, 0, 0
.short 8364, 11480, 10440, 10440, 10440, 400, 0, 0, 10440, 9400, 8360, 8360, 8360, 408, 0, 0
.short 8360, 11476, 10436, 10436, 10436, 416, 0, 0, 10436, 9396, 8356, 8356, 8356, 424, 0, 0
.short 8356, 11472, 10432, 10432, 10432, 432, 0, 0, 10432, 9392, 8352, 8352, 8352, 440, 0, 0
.short 8352, 11468, 10428, 10428, 10428, 448, 0, 0, 10428, 9388, 8348, 8348, 8348, 456, 0, 0
.short 8348, 11464, 10424, 10424, 10424, 464, 0, 0, 10424, 9384, 8344, 8344, 8344, 472, 0, 0
.short 8344, 11460, 10420, 10420, 10420, 480, 0, 0, 10420, 9380, 8340, 8340, 8340, 488, 0, 0
.short 8340, 11456, 10416, 10416, 10416, 496, 0, 0, 10416, 9376, 8336, 8336, 8336, 504, 0, 0
.short 8336, 11452, 10412, 10412, 10412, 512, 0, 0, 10412, 9372, 8332, 8332, 8332, 520, 0, 0
.short 8332, 11448, 10408, 10408, 10408, 528, 0, 0, 10408, 9368, 8328, 8328, 8328, 536, 0, 0
.short 8328, 11444, 10404, 10404, 10404, 544, 0, 0, 10404, 9364, 8324, 8324, 8324, 552, 0, 0
.short 8324, 11440, 10400, 10400, 10400, 560, 0, 0, 10400, 9360, 8320, 8320, 7404, 568, 0, 0
.short 7404, 6364, 5324, 4284, 3244, 576, 0, 0, 3244, 2204, 1164, 124, 7400, 584, 0, 0
.short 7400, 6360, 5320, 4280, 3240, 592, 0, 0, 3240, 2200, 1160, 120, 7396, 600, 0, 0
.short 7396, 6356, 5316, 4276, 3236, 608, 0, 0, 3236, 2196, 1156, 116, 7392, 616, 0, 0
.short 7392, 6352, 5312, 4272, 3232, 624, 0, 0, 3232, 2192, 1152, 112, 7388, 632, 0, 0
.short 7388, 6348, 5308, 4268, 3228, 640, 0, 0, 3228, 2188, 1148, 108, 7384, 648, 0, 0
.short 7384, 6344, 5304, 4264, 3224, 656, 0, 0, 3224, 2184, 1144, 104, 7380, 664, 0, 0
.short 7380, 6340, 5300, 4260, 3220, 672, 0, 0, 3220, 2180, 1140, 100, 7376, 680, 0, 0
.short 7376, 6336, 5296, 4256, 3216, 688, 0, 0, 3216, 2176, 1136, 96, 7372, 696, 0, 0
.short 7372, 6332, 5292, 4252, 3212, 704, 0, 0, 3212, 2172, 1132, 92, 7368, 712, 0, 0
.short 7368, 6328, 5288, 4248, 3208, 720, 0, 0, 3208, 2168, 1128, 88, 7364, 728, 0, 0
.short 7364, 6324, 5284, 4244, 3204, 736, 0, 0, 3204, 2164, 1124, 84, 7360, 744, 0, 0
.short 7360, 6320, 5280, 4240, 3200, 752, 0, 0, 3200, 2160, 1120, 80, 7356, 760, 0, 0
.short 7356, 6316, 5276, 4236, 3196, 768, 0, 0, 3196, 2156, 1116, 76, 7352, 776, 0, 0
.short 7352, 6312, 5272, 4232, 3192, 784, 0, 0, 3192, 2152, 1112, 72, 7348, 792, 0, 0
.short 7348, 6308, 5268, 4228, 3188, 800, 0, 0, 3188, 2148, 1108, 68, 7344, 808, 0, 0
.short 7344, 6304, 5264, 4224, 3184, 816, 0, 0, 3184, 2144, 1104, 64, 7340, 824, 0, 0
.short 7340, 6300, 5260, 4220, 3180, 832, 0, 0, 3180, 2140, 1100, 60, 7336, 840, 0, 0
.short 7336, 6296, 5256, 4216, 3176, 848, 0, 0, 3176, 2136, 1096, 56, 7332, 856, 0, 0
.short 7332, 6292, 5252, 4212, 3172, 864, 0, 0, 3172, 2132, 1092, 52, 7328, 872, 0, 0
.short 7328, 6288, 5248, 4208, 3168, 880, 0, 0, 3168, 2128, 1088, 48, 7324, 888, 0, 0
.short 7324, 6284, 5244, 4204, 3164, 896, 0, 0, 3164, 2124, 1084, 44, 7320, 904, 0, 0
.short 7320, 6280, 5240, 4200, 3160, 912, 0, 0, 3160, 2120, 1080, 40, 7316, 920, 0, 0
.short 7316, 6276, 5236, 4196, 3156, 928, 0, 0, 3156, 2116, 1076, 36, 7312, 936, 0, 0
.short 7312, 6272, 5232, 4192, 3152, 944, 0, 0, 3152, 2112, 1072, 32, 7308, 952, 0, 0
.short 7308, 6268, 5228, 4188, 3148, 960, 0, 0, 3148, 2108, 1068, 28, 7304, 968, 0, 0
.short 7304, 6264, 5224, 4184, 3144, 976, 0, 0, 3144, 2104, 1064, 24, 7300, 984, 0, 0
.short 7300, 6260, 5220, 4180, 3140, 992, 0, 0, 3140, 2100, 1060, 20, 7296, 1000, 0, 0
.short 7296, 6256, 5216, 4176, 3136, 1008, 0, 0, 3136, 2096, 1056, 16, 7292, 1016, 0, 0
.short 7292, 6252, 5212, 4172, 3132, 1024, 0, 0, 3132, 2092, 1052, 12, 7288, 1032, 0, 0
.short 7288, 6248, 5208, 4168, 3128, 1040, 0, 0, 3128, 2088, 1048, 8, 7284, 1048, 0, 0
.short 7284, 6244, 5204, 4164, 3124, 1056, 0, 0, 3124, 2084, 1044, 4, 7280, 1064, 0, 0
.short 7280, 6240, 5200, 4160, 3120, 1072, 0, 0, 3120, 2080, 1040, 0, 128, 1080, 0, 0
.short 128, 128, 128, 128, 128, 1088, 0, 0, 128, 128, 128, 128, 128, 1096, 0, 0
.short 128, 128, 128, 128, 128, 1104, 0, 0, 128, 128, 128, 128, 128, 1112, 0, 0
.short 128, 128, 128, 128, 128, 2320, 0, 0, 128, 128, 128, 128, 128, 2328, 0, 0
.short 128, 128, 128, 128, 128, 2336, 0, 0, 128, 128, 128, 128, 128, 2344, 0, 0
.short 128, 128, 128, 128, 128, 2352, 0, 0, 128, 128, 128, 128, 128, 2360, 0, 0
.short 128, 128, 128, 128, 128, 2368, 0, 0, 128, 128, 128, 128, 128, 2376, 0, 0
.short 16640, 15724, 13640, 15716, 128, 2384, 0, 0, 13632, 15708, 13624, 15700, 128, 2392, 0, 0
.short 13616, 15692, 13608, 15684, 128, 2400, 0, 0, 13600, 15676, 13592, 15668, 128, 2408, 0, 0
.short 13584, 15660, 13576, 15652, 128, 2416, 0, 0, 13568, 15644, 13560, 15636, 128, 2424, 0, 0
.short 13552, 15628, 13544, 15620, 128, 2432, 0, 0, 13536, 15612, 13528, 15604, 128, 2440, 0, 0
.short 13520, 14684, 12600, 14676, 128, 2448, 0, 0, 12592, 14668, 12584, 14660, 128, 2456, 0, 0
.short 12576, 14652, 12568, 14644, 128, 2464, 0, 0, 12560, 14636, 12552, 14628, 128, 2472, 0, 0
.short 12544, 14620, 12536, 14612, 128, 2480, 0, 0, 12528, 14604, 12520, 14596, 128, 2488, 0, 0
.short 12512, 14588, 12504, 14580, 128, 2496, 0, 0, 12496, 14572, 12488, 14564, 128, 2504, 0, 0
.short 128, 128, 128, 128, 128, 2512, 0, 0, 128, 128, 128, 128, 128, 2520, 0, 0
.short 128, 128, 128, 128, 128, 2528, 0, 0, 128, 128, 128, 128, 128, 2536, 0, 0
.short 128, 128, 128, 128, 128, 2544, 0, 0, 128, 128, 128, 128, 128, 2552, 0, 0
.short 128, 128, 128, 128, 128, 2560, 0, 0, 128, 128, 128, 128, 128, 2568, 0, 0
.short 128, 128, 128, 128, 128, 2576, 0, 0, 128, 128, 128, 128, 128, 2584, 0, 0
.short 128, 128, 128, 128, 128, 2592, 0, 0, 128, 128, 128, 128, 128, 2600, 0, 0
.short 128, 128, 128, 128, 128, 2608, 0, 0, 128, 128, 128, 128, 128, 2616, 0, 0
.short 128, 128, 128, 128, 128, 2624, 0, 0, 128, 128, 128, 128, 128, 2632, 0, 0
.short 13644, 15720, 13636, 15712, 128, 2640, 0, 0, 13628, 15704, 13620, 15696, 128, 2648, 0, 0
.short 13612, 15688, 13604, 15680, 128, 2656, 0, 0, 13596, 15672, 13588, 15664, 128, 2664, 0, 0
.short 13580, 15656, 13572, 15648, 128, 2672, 0, 0, 13564, 15640, 13556, 15632, 128, 2680, 0, 0
.short 13548, 15624, 13540, 15616, 128, 2688, 0, 0, 13532, 15608, 13524, 15600, 128, 2696, 0, 0
.short 12604, 14680, 12596, 14672, 128, 2704, 0, 0, 12588, 14664, 12580, 14656, 128, 2712, 0, 0
.short 12572, 14648, 12564, 14640, 128, 2720, 0, 0, 12556, 14632, 12548, 14624, 128, 2728, 0, 0
.short 12540, 14616, 12532, 14608, 128, 2736, 0, 0, 12524, 14600, 12516, 14592, 128, 2744, 0, 0
.short 12508, 14584, 12500, 14576, 128, 2752, 0, 0, 12492, 14568, 12484, 14560, 128, 2760, 0, 0
.short 128, 128, 128, 128, 128, 2768, 0, 0, 128, 128, 128, 128, 128, 2776, 0, 0
.short 128, 128, 128, 128, 128, 2784, 0, 0, 128, 128, 128, 128, 128, 2792, 0, 0
.short 128, 128, 128, 128, 128, 2800, 0, 0, 128, 128, 128, 128, 128, 2808, 0, 0
.short 128, 128, 128, 128, 128, 2816, 0, 0, 128, 128, 128, 128, 128, 2824, 0, 0
.short 20800, 19884, 19880, 19876, 128, 2832, 0, 0, 19872, 19868, 19864, 19860, 128, 2840, 0, 0
.short 19856, 19852, 19848, 19844, 128, 2848, 0, 0, 19840, 19836, 19832, 19828, 128, 2856, 0, 0
.short 19824, 19820, 19816, 19812, 128, 2864, 0, 0, 19808, 19804, 19800, 19796, 128, 2872, 0, 0
.short 19792, 19788, 19784, 19780, 128, 2880, 0, 0, 19776, 19772, 19768, 19764, 128, 2888, 0, 0
.short 19760, 18844, 18840, 18836, 128, 2896, 0, 0, 18832, 18828, 18824, 18820, 128, 2904, 0, 0
.short 18816, 18812, 18808, 18804, 128, 2912, 0, 0, 18800, 18796, 18792, 18788, 128, 2920, 0, 0
.short 18784, 18780, 18776, 18772, 128, 2928, 0, 0, 18768, 18764, 18760, 18756, 128, 2936, 0, 0
.short 18752, 18748, 18744, 18740, 128, 2944, 0, 0, 18736, 18732, 18728, 18724, 128, 2952, 0, 0
.short 18720, 17804, 17800, 17796, 128, 2960, 0, 0, 17792, 17788, 17784, 17780, 128, 2968, 0, 0
.short 17776, 17772, 17768, 17764, 128, 2976, 0, 0, 17760, 17756, 17752, 17748, 128, 2984, 0, 0
.short 17744, 17740, 17736, 17732, 128, 2992, 0, 0, 17728, 17724, 17720, 17716, 128, 3000, 0, 0
.short 17712, 17708, 17704, 17700, 128, 3008, 0, 0, 17696, 17692, 17688, 17684, 128, 3016, 0, 0
.short 17680, 16764, 16760, 16756, 128, 3024, 0, 0, 16752, 16748, 16744, 16740, 128, 3032, 0, 0
.short 16736, 16732, 16728, 16724, 128, 3040, 0, 0, 16720, 16716, 16712, 16708, 128, 3048, 0, 0
.short 16704, 16700, 16696, 16692, 128, 3056, 0, 0, 16688, 16684, 16680, 16676, 128, 3064, 0, 0
.short 16672, 16668, 16664, 16660, 128, 3072, 0, 0, 16656, 16652, 16648, 16644, 128, 3080, 0, 0
.short 128, 128, 128, 128, 128, 3088, 0, 0, 128, 128, 128, 128, 128, 3096, 0, 0
.short 128, 128, 128, 128, 128, 3104, 0, 0, 128, 128, 128, 128, 128, 3112, 0, 0
.short 128, 128, 128, 128, 128, 3120, 0, 0, 128, 128, 128, 128, 128, 3128, 0, 0
.short 128, 128, 128, 128, 128, 3136, 0, 0, 128, 128, 128, 128, 128, 3144, 0, 0
.short 16640, 16640, 16640, 16640, 128, 3152, 0, 0, 16640, 16640, 16640, 16640, 128, 3160, 0, 0
.short 16640, 16640, 16640, 16640, 128, 3168, 0, 0, 16640, 16640, 16640, 16640, 128, 3176, 0, 0
.short 16640, 16640, 16640, 16640, 128, 3184, 0, 0, 16640, 16640, 16640, 16640, 128, 3192, 0, 0
.short 16640, 16640, 16640, 16640, 128, 3200, 0, 0, 16640, 16640, 16640, 16640, 128, 3208, 0, 0
.short 16640, 16640, 16640, 16640, 128, 3216, 0, 0, 16640, 16640, 16640, 16640, 128, 3224, 0, 0
.short 16640, 16640, 16640, 16640, 128, 3232, 0, 0, 16640, 16640, 16640, 16640, 128, 3240, 0, 0
.short 0, 0, 0, 0, 0, 0, 16256, 16256, 0, 0, 0, 0, 0, 0, 0, 16256
.short 0, 0, 0, 0, 0, 0, 0, 0, 0, 0, 0, 0, 0, 0, 0, 0
.short 0, 0, 0, 0, 0, 0, 0, 0, 0, 0, 0, 0, 0, 0, 0, 0
.short 0, 0, 0, 0, 0, 0, 0, 0, 0, 0, 0, 0, 0, 0, 0, 0
.short 0, 0, 0, 0, 0, 0, 0, 0, 0, 0, 0, 0, 0, 0, 0, 0
.short 0, 0, 0, 0, 0, 0, 0, 0, 0, 0, 0, 0, 0, 0, 0, 0
.short 0, 0, 0, 0, 0, 0, 0, 0, 0, 0, 0, 0, 0, 0, 0, 0
.short 0, 0, 0, 0, 0, 0, 0, 0, 0, 0, 0, 0, 0, 0, 0, 0
.short 16256, 16256, 16256, 0, 0, 0, 0, 0, 16256, 16256, 16256, 16256, 0, 0, 0, 0
.short 16256, 16256, 16256, 16256, 16256, 0, 0, 0, 0, 16256, 16256, 16256, 16256, 16256, 0, 0
.short 0, 0, 16256, 16256, 16256, 16256, 16256, 0, 0, 0, 0, 16256, 16256, 16256, 16256, 16256
.short 0, 0, 0, 0, 16256, 16256, 16256, 16256, 0, 0, 0, 0, 0, 16256, 16256, 16256
.short 0, 0, 0, 0, 0, 0, 16256, 16256, 0, 0, 0, 0, 0, 0, 0, 16256
.short 0, 0, 0, 0, 0, 0, 0, 0, 0, 0, 0, 0, 0, 0, 0, 0
.short 0, 0, 0, 0, 0, 0, 0, 0, 0, 0, 0, 0, 0, 0, 0, 0
.short 0, 0, 0, 0, 0, 0, 0, 0, 0, 0, 0, 0, 0, 0, 0, 0
.short 0, 0, 0, 0, 0, 0, 0, 0, 0, 0, 0, 0, 0, 0, 0, 0
.short 0, 0, 0, 0, 0, 0, 0, 0, 0, 0, 0, 0, 0, 0, 0, 0
.short 0, 0, 0, 0, 0, 0, 0, 0, 0, 0, 0, 0, 0, 0, 0, 0
.short 16256, 0, 0, 0, 0, 0, 0, 0, 16256, 16256, 0, 0, 0, 0, 0, 0
.short 16256, 16256, 16256, 0, 0, 0, 0, 0, 16256, 16256, 16256, 16256, 0, 0, 0, 0
.short 16256, 16256, 16256, 16256, 16256, 0, 0, 0, 0, 16256, 16256, 16256, 16256, 16256, 0, 0
.short 0, 0, 16256, 16256, 16256, 16256, 16256, 0, 0, 0, 0, 16256, 16256, 16256, 16256, 16256
.short 0, 0, 0, 0, 16256, 16256, 16256, 16256, 0, 0, 0, 0, 0, 16256, 16256, 16256
.short 0, 0, 0, 0, 0, 0, 0, 0, 0, 0, 0, 0, 0, 0, 0, 0
.short 0, 0, 0, 0, 0, 0, 0, 0, 0, 0, 0, 0, 0, 0, 0, 0
.short 0, 0, 0, 0, 0, 0, 0, 0, 0, 0, 0, 0, 0, 0, 0, 0
.short 0, 0, 0, 0, 0, 0, 0, 0, 0, 0, 0, 0, 0, 0, 0, 0
.short 0, 0, 0, 0, 0, 0, 0, 0, 0, 0, 0, 0, 0, 0, 0, 0
.short 0, 0, 0, 0, 0, 0, 0, 0, 0, 0, 0, 0, 0, 0, 0, 0
.short 0, 0, 0, 0, 0, 0, 0, 0, 0, 0, 0, 0, 0, 0, 0, 0
.short 16256, 0, 0, 0, 0, 0, 0, 0, 16256, 16256, 0, 0, 0, 0, 0, 0
.short 0, 0, 0, 0, 0, 0, 0, 0, 0, 0, 0, 0, 0, 0, 0, 0
.short 0, 0, 0, 0, 0, 0, 0, 0, 0, 0, 0, 0, 0, 0, 0, 0
.short 0, 0, 0, 0, 0, 0, 0, 0, 0, 0, 0, 0, 0, 0, 0, 0
.short 0, 0, 0, 0, 0, 0, 0, 0, 0, 0, 0, 0, 0, 0, 0, 0
.short 0, 0, 0, 0, 0, 0, 0, 0, 0, 0, 0, 0, 0, 0, 0, 0
.short 0, 0, 0, 0, 0, 0, 0, 0, 0, 0, 0, 0, 0, 0, 0, 0
.short 0, 0, 0, 0, 0, 0, 0, 0, 0, 0, 0, 0, 0, 0, 0, 0
.short 0, 0, 0, 0, 0, 0, 0, 0, 0, 0, 0, 0, 0, 0, 0, 0
.short 0, 0, 0, 16256, 16256, 16256, 0, 0, 0, 0, 0, 0, 16256, 16256, 16256, 0
.short 0, 0, 0, 0, 0, 16256, 16256, 16256, 0, 0, 0, 0, 0, 0, 16256, 16256
.short 0, 0, 0, 0, 0, 0, 0, 16256, 0, 0, 0, 0, 0, 0, 0, 0
.short 0, 0, 0, 0, 0, 0, 0, 0, 0, 0, 0, 0, 0, 0, 0, 0
.short 0, 0, 0, 0, 0, 0, 0, 0, 0, 0, 0, 0, 0, 0, 0, 0
.short 0, 0, 0, 0, 0, 0, 0, 0, 0, 0, 0, 0, 0, 0, 0, 0
.short 0, 0, 0, 0, 0, 0, 0, 0, 0, 0, 0, 0, 0, 0, 0, 0
.short 0, 0, 0, 0, 0, 0, 0, 0, 0, 0, 0, 0, 0, 0, 0, 0
.short 0, 0, 0, 0, 0, 0, 0, 0, 0, 0, 0, 0, 0, 0, 0, 0
.short 0, 0, 0, 0, 0, 0, 0, 0, 16256, 0, 0, 0, 0, 0, 0, 0
.short 16256, 16256, 0, 0, 0, 0, 0, 0, 16256, 16256, 16256, 0, 0, 0, 0, 0
.short 0, 16256, 16256, 16256, 0, 0, 0, 0, 0, 0, 16256, 16256, 16256, 0, 0, 0
.short 0, 0, 0, 16256, 16256, 16256, 0, 0, 0, 0, 0, 0, 16256, 16256, 16256, 0
.short 0, 0, 0, 0, 0, 16256, 16256, 16256, 0, 0, 0, 0, 0, 0, 16256, 16256
.short 0, 0, 0, 0, 0, 0, 0, 16256, 0, 0, 0, 0, 0, 0, 0, 0
.short 0, 0, 0, 0, 0, 0, 0, 0, 0, 0, 0, 0, 0, 0, 0, 0
.short 0, 0, 0, 0, 0, 0, 0, 0, 0, 0, 0, 0, 0, 0, 0, 0
.short 0, 0, 0, 0, 0, 0, 0, 0, 0, 0, 0, 0, 0, 0, 0, 0
.short 0, 0, 0, 0, 0, 0, 0, 0, 0, 0, 0, 0, 0, 0, 0, 0
.short 0, 0, 0, 0, 0, 0, 0, 0, 0, 0, 0, 0, 0, 0, 0, 0
.short 0, 0, 0, 0, 0, 0, 0, 0, 0, 0, 0, 0, 0, 0, 0, 0
.short 0, 0, 0, 0, 0, 0, 0, 0, 16256, 0, 0, 0, 0, 0, 0, 0
.short 16256, 16256, 0, 0, 0, 0, 0, 0, 16256, 16256, 16256, 0, 0, 0, 0, 0
.short 0, 16256, 16256, 16256, 0, 0, 0, 0, 0, 0, 16256, 16256, 16256, 0, 0, 0
.short 0, 0, 0, 0, 16256, 16256, 16256, 16256, 0, 0, 0, 0, 0, 16256, 16256, 16256
.short 0, 0, 0, 0, 0, 0, 16256, 16256, 0, 0, 0, 0, 0, 0, 0, 16256
.short 0, 0, 0, 0, 0, 0, 0, 0, 0, 0, 0, 0, 0, 0, 0, 0
.short 0, 0, 0, 0, 0, 0, 0, 0, 0, 0, 0, 0, 0, 0, 0, 0
.short 0, 0, 0, 0, 0, 0, 0, 0, 0, 0, 0, 0, 0, 0, 0, 0
.short 0, 0, 0, 0, 0, 0, 0, 0, 0, 0, 0, 0, 0, 0, 0, 0
.short 0, 0, 0, 0, 0, 0, 0, 0, 0, 0, 0, 0, 0, 0, 0, 0
.short 0, 0, 0, 0, 0, 0, 0, 0, 0, 0, 0, 0, 0, 0, 0, 0
.short 16256, 16256, 16256, 16256, 16256, 0, 0, 0, 16256, 16256, 16256, 16256, 16256, 16256, 0, 0
.short 16256, 16256, 16256, 16256, 16256, 16256, 16256, 0, 16256, 16256, 16256, 16256, 16256, 16256, 16256, 16256
.short 16256, 16256, 16256, 16256, 16256, 16256, 16256, 16256, 0, 16256, 16256, 16256, 16256, 16256, 16256, 16256
.short 0, 0, 16256, 16256, 16256, 16256, 16256, 16256, 0, 0, 0, 16256, 16256, 16256, 16256, 16256
.short 0, 0, 0, 0, 16256, 16256, 16256, 16256, 0, 0, 0, 0, 0, 16256, 16256, 16256
.short 0, 0, 0, 0, 0, 0, 16256, 16256, 0, 0, 0, 0, 0, 0, 0, 16256
.short 0, 0, 0, 0, 0, 0, 0, 0, 0, 0, 0, 0, 0, 0, 0, 0
.short 0, 0, 0, 0, 0, 0, 0, 0, 0, 0, 0, 0, 0, 0, 0, 0
.short 0, 0, 0, 0, 0, 0, 0, 0, 0, 0, 0, 0, 0, 0, 0, 0
.short 0, 0, 0, 0, 0, 0, 0, 0, 0, 0, 0, 0, 0, 0, 0, 0
.short 16256, 0, 0, 0, 0, 0, 0, 0, 16256, 16256, 0, 0, 0, 0, 0, 0
.short 16256, 16256, 16256, 0, 0, 0, 0, 0, 16256, 16256, 16256, 16256, 0, 0, 0, 0
.short 16256, 16256, 16256, 16256, 16256, 0, 0, 0, 16256, 16256, 16256, 16256, 16256, 16256, 0, 0
.short 16256, 16256, 16256, 16256, 16256, 16256, 16256, 0, 16256, 16256, 16256, 16256, 16256, 16256, 16256, 16256
.short 16256, 16256, 16256, 16256, 16256, 16256, 16256, 16256, 0, 16256, 16256, 16256, 16256, 16256, 16256, 16256
.short 0, 0, 16256, 16256, 16256, 16256, 16256, 16256, 0, 0, 0, 16256, 16256, 16256, 16256, 16256
.short 0, 0, 0, 0, 0, 0, 0, 0, 0, 0, 0, 0, 0, 0, 0, 0
.short 0, 0, 0, 0, 0, 0, 0, 0, 0, 0, 0, 0, 0, 0, 0, 0
.short 0, 0, 0, 0, 0, 0, 0, 0, 0, 0, 0, 0, 0, 0, 0, 0
.short 0, 0, 0, 0, 0, 0, 0, 0, 0, 0, 0, 0, 0, 0, 0, 0
.short 0, 0, 0, 0, 0, 0, 0, 0, 0, 0, 0, 0, 0, 0, 0, 0
.short 0, 0, 0, 0, 0, 0, 0, 0, 0, 0, 0, 0, 0, 0, 0, 0
.short 16256, 0, 0, 0, 0, 0, 0, 0, 16256, 16256, 0, 0, 0, 0, 0, 0
.short 16256, 16256, 16256, 0, 0, 0, 0, 0, 16256, 16256, 16256, 16256, 0, 0, 0, 0
.short 0, 0, 0, 0, 0, 16256, 16256, 16256, 0, 0, 0, 0, 0, 0, 16256, 16256
.short 0, 0, 0, 0, 0, 0, 0, 16256, 0, 0, 0, 0, 0, 0, 0, 0
.short 0, 0, 0, 0, 0, 0, 0, 0, 0, 0, 0, 0, 0, 0, 0, 0
.short 0, 0, 0, 0, 0, 0, 0, 0, 0, 0, 0, 0, 0, 0, 0, 0
.short 0, 0, 0, 0, 0, 0, 0, 0, 0, 0, 0, 0, 0, 0, 0, 0
.short 0, 0, 0, 0, 0, 0, 0, 0, 0, 0, 0, 0, 0, 0, 0, 0
.short 0, 0, 0, 0, 0, 0, 0, 0, 0, 0, 0, 0, 0, 0, 0, 0
.short 0, 0, 0, 0, 0, 0, 0, 0, 0, 0, 0, 0, 0, 0, 0, 0
.short 16256, 16256, 16256, 16256, 0, 0, 0, 0, 16256, 16256, 16256, 16256, 16256, 0, 0, 0
.short 16256, 16256, 16256, 16256, 16256, 16256, 0, 0, 16256, 16256, 16256, 16256, 16256, 16256, 16256, 0
.short 0, 16256, 16256, 16256, 16256, 16256, 16256, 16256, 0, 0, 16256, 16256, 16256, 16256, 16256, 16256
.short 0, 0, 0, 16256, 16256, 16256, 16256, 16256, 0, 0, 0, 0, 16256, 16256, 16256, 16256
.short 0, 0, 0, 0, 0, 16256, 16256, 16256, 0, 0, 0, 0, 0, 0, 16256, 16256
.short 0, 0, 0, 0, 0, 0, 0, 16256, 0, 0, 0, 0, 0, 0, 0, 0
.short 0, 0, 0, 0, 0, 0, 0, 0, 0, 0, 0, 0, 0, 0, 0, 0
.short 0, 0, 0, 0, 0, 0, 0, 0, 0, 0, 0, 0, 0, 0, 0, 0
.short 0, 0, 0, 0, 0, 0, 0, 0, 0, 0, 0, 0, 0, 0, 0, 0
.short 0, 0, 0, 0, 0, 0, 0, 0, 0, 0, 0, 0, 0, 0, 0, 0
.short 0, 0, 0, 0, 0, 0, 0, 0, 16256, 0, 0, 0, 0, 0, 0, 0
.short 16256, 16256, 0, 0, 0, 0, 0, 0, 16256, 16256, 16256, 0, 0, 0, 0, 0
.short 16256, 16256, 16256, 16256, 0, 0, 0, 0, 16256, 16256, 16256, 16256, 16256, 0, 0, 0
.short 16256, 16256, 16256, 16256, 16256, 16256, 0, 0, 16256, 16256, 16256, 16256, 16256, 16256, 16256, 0
.short 0, 16256, 16256, 16256, 16256, 16256, 16256, 16256, 0, 0, 16256, 16256, 16256, 16256, 16256, 16256
.short 0, 0, 0, 16256, 16256, 16256, 16256, 16256, 0, 0, 0, 0, 16256, 16256, 16256, 16256
.short 0, 0, 0, 0, 0, 0, 0, 0, 0, 0, 0, 0, 0, 0, 0, 0
.short 0, 0, 0, 0, 0, 0, 0, 0, 0, 0, 0, 0, 0, 0, 0, 0
.short 0, 0, 0, 0, 0, 0, 0, 0, 0, 0, 0, 0, 0, 0, 0, 0
.short 0, 0, 0, 0, 0, 0, 0, 0, 0, 0, 0, 0, 0, 0, 0, 0
.short 0, 0, 0, 0, 0, 0, 0, 0, 0, 0, 0, 0, 0, 0, 0, 0
.short 0, 0, 0, 0, 0, 0, 0, 0, 0, 0, 0, 0, 0, 0, 0, 0
.short 0, 0, 0, 0, 0, 0, 0, 0, 16256, 0, 0, 0, 0, 0, 0, 0
.short 16256, 16256, 0, 0, 0, 0, 0, 0, 16256, 16256, 16256, 0, 0, 0, 0, 0
.short 0, 0, 0, 0, 0, 0, 0, 0, 0, 0, 0, 0, 0, 0, 0, 0
.short 0, 0, 0, 0, 0, 0, 0, 0, 0, 0, 0, 0, 0, 0, 0, 0
.short 0, 0, 0, 0, 0, 0, 0, 0, 0, 0, 0, 0, 0, 0, 0, 0
.short 0, 0, 0, 0, 0, 0, 0, 0, 0, 0, 0, 0, 0, 0, 0, 0
.short 0, 0, 0, 0, 0, 0, 0, 0, 0, 0, 0, 0, 0, 0, 0, 0
.short 0, 0, 0, 0, 0, 0, 0, 0, 0, 0, 0, 0, 0, 0, 0, 0
.short 0, 0, 0, 0, 0, 0, 0, 0, 0, 0, 0, 0, 0, 0, 0, 0
.short 0, 0, 0, 0, 0, 0, 0, 0, 0, 0, 0, 0, 0, 0, 0, 0
.short 0, 0, 0, 0, 65535, 65535, 0, 0, 0, 0, 0, 0, 0, 65535, 65535, 0
.short 0, 0, 0, 0, 0, 0, 65535, 65535, 0, 0, 0, 0, 0, 0, 0, 65535
.short 0, 0, 0, 0, 0, 0, 0, 0, 0, 0, 0, 0, 0, 0, 0, 0
.short 0, 0, 0, 0, 0, 0, 0, 0, 0, 0, 0, 0, 0, 0, 0, 0
.short 0, 0, 0, 0, 0, 0, 0, 0, 0, 0, 0, 0, 0, 0, 0, 0
.short 0, 0, 0, 0, 0, 0, 0, 0, 0, 0, 0, 0, 0, 0, 0, 0
.short 0, 0, 0, 0, 0, 0, 0, 0, 0, 0, 0, 0, 0, 0, 0, 0
.short 0, 0, 0, 0, 0, 0, 0, 0, 0, 0, 0, 0, 0, 0, 0, 0
.short 0, 0, 0, 0, 0, 0, 0, 0, 0, 0, 0, 0, 0, 0, 0, 0
.short 0, 0, 0, 0, 0, 0, 0, 0, 65535, 0, 0, 0, 0, 0, 0, 0
.short 65535, 65535, 0, 0, 0, 0, 0, 0, 0, 65535, 65535, 0, 0, 0, 0, 0
.short 0, 0, 65535, 65535, 0, 0, 0, 0, 0, 0, 0, 65535, 65535, 0, 0, 0
.short 0, 0, 0, 0, 65535, 65535, 0, 0, 0, 0, 0, 0, 0, 65535, 65535, 0
.short 0, 0, 0, 0, 0, 0, 65535, 65535, 0, 0, 0, 0, 0, 0, 0, 65535
.short 0, 0, 0, 0, 0, 0, 0, 0, 0, 0, 0, 0, 0, 0, 0, 0
.short 0, 0, 0, 0, 0, 0, 0, 0, 0, 0, 0, 0, 0, 0, 0, 0
.short 0, 0, 0, 0, 0, 0, 0, 0, 0, 0, 0, 0, 0, 0, 0, 0
.short 0, 0, 0, 0, 0, 0, 0, 0, 0, 0, 0, 0, 0, 0, 0, 0
.short 0, 0, 0, 0, 0, 0, 0, 0, 0, 0, 0, 0, 0, 0, 0, 0
.short 0, 0, 0, 0, 0, 0, 0, 0, 0, 0, 0, 0, 0, 0, 0, 0
.short 0, 0, 0, 0, 0, 0, 0, 0, 0, 0, 0, 0, 0, 0, 0, 0
.short 0, 0, 0, 0, 0, 0, 0, 0, 65535, 0, 0, 0, 0, 0, 0, 0
.short 65535, 65535, 0, 0, 0, 0, 0, 0, 0, 65535, 65535, 0, 0, 0, 0, 0
.short 0, 0, 65535, 65535, 0, 0, 0, 0, 0, 0, 0, 65535, 65535, 0, 0, 0
.size ktab, 9216
code_end:
.section .rodata,"a"
.p2align 6
.amdhsa_kernel adaLN_cond__ssm_conv_s4__glu_gated_reglu__prompt_kernel
  .amdhsa_next_free_vgpr 256
  .amdhsa_next_free_sgpr 80
  .amdhsa_accum_offset 256
  .amdhsa_group_segment_fixed_size 0
  .amdhsa_kernarg_size 144
  .amdhsa_user_sgpr_count 2
  .amdhsa_user_sgpr_kernarg_segment_ptr 1
  .amdhsa_system_sgpr_workgroup_id_x 1
.end_amdhsa_kernel
```
